```python
import torch

def _softmax(x, axis=-1):
    return torch.softmax(x, dim=axis)
def _gelu(x):
    return torch.nn.functional.gelu(x, approximate="tanh")
def _silu(x):
    return torch.nn.functional.silu(x)
def _sigmoid(x):
    return torch.sigmoid(x)
def _layernorm(x, axis=-1, eps=1e-5):
    m = x.mean(dim=axis, keepdim=True)
    v = x.var(dim=axis, keepdim=True, unbiased=False)
    return (x - m) / torch.sqrt(v + eps)
def _scatter_add(tgt, idx, src, axis=0):
    return tgt.clone().index_add_(axis, idx, src)
def _segment_sum(src, seg, n):
    out = torch.zeros((n,) + src.shape[1:], dtype=src.dtype)
    return out.index_add_(0, seg, src)
def _pad(x, pw):
    flat = tuple(v for pair in reversed(pw) for v in pair)
    return torch.nn.functional.pad(x, flat)

kernel_name = 'recurrent_scan__mha_block_cached__swiglu_ffn__decode'

def setup_inputs():

    _w = (lambda a: (lambda t: t.to(torch.bfloat16) if t.is_floating_point() else t)(torch.as_tensor(a)))
    def _A_setup():
        B, Sq, D = 1, 1, 640
        H, Sk, Dh = 32, 4096, 192
        return {
            "x": _w((lambda *s: torch.randn(*s, dtype=torch.bfloat16) * 0.05)(B, Sq, D)),
            "k_cache": _w((lambda *s: torch.randn(*s, dtype=torch.bfloat16) * 1.6)(B, H, Sk, Dh)),
            "v_cache": _w((lambda *s: torch.randn(*s, dtype=torch.bfloat16) * 0.2)(B, H, Sk, Dh)),
            "wq": _w((lambda *s: torch.randn(*s, dtype=torch.bfloat16) * 1.6)(D, H * Dh) * (D ** -0.5)),
            "wo": _w((lambda *s: torch.randn(*s, dtype=torch.bfloat16) * 0.2)(H * Dh, D) * ((H * Dh) ** -0.5)),
        }
    _A_in = _A_setup()

    def _B_setup():
        B, S, D, F = 1, 1, 640, 1536
        return {
            "x": _w((lambda *s: torch.randn(*s, dtype=torch.bfloat16) * 0.05)(B, S, D)),
            "w_gate": _w((lambda *s: torch.randn(*s, dtype=torch.bfloat16) * 0.1)(D, F)),
            "w_up": _w((lambda *s: torch.randn(*s, dtype=torch.bfloat16) * 0.1)(D, F)),
            "w_down": _w((lambda *s: torch.randn(*s, dtype=torch.bfloat16) * 0.1)(F, D)),
        }
    _B_in = _B_setup()

    return {
        "A_x": _A_in["x"],
        "A_k_cache": _A_in["k_cache"],
        "A_v_cache": _A_in["v_cache"],
        "A_wq": _A_in["wq"],
        "A_wo": _A_in["wo"],
        "B_x": _B_in["x"],
        "B_w_gate": _B_in["w_gate"],
        "B_w_up": _B_in["w_up"],
        "B_w_down": _B_in["w_down"],
    }

def reference(A_x, A_k_cache, A_v_cache, A_wq, A_wo, B_x, B_w_gate, B_w_up, B_w_down):
    def _A_ref(x, k_cache, v_cache, wq, wo):
        B, Sq, D = x.shape
        H, Dh = 32, 192
        q = (lambda x, *d: x.permute(*d))((x @ wq).reshape(B, Sq, H, Dh), 0, 2, 1, 3)
        scores = torch.einsum("bhqd,bhkd->bhqk", q, k_cache) * (Dh ** -0.5)
        p = _softmax(scores, axis=-1)
        o = torch.einsum("bhqk,bhkd->bhqd", p, v_cache)
        return (lambda x, *d: x.permute(*d))(o, 0, 2, 1, 3).reshape(B, Sq, H * Dh) @ wo

    def _B_ref(x, w_gate, w_up, w_down):
        g = _silu(x @ w_gate)
        u = x @ w_up
        return (g * u) @ w_down

    x = A_x
    xn = _layernorm(x, axis=-1)
    s = _A_ref(xn, A_k_cache, A_v_cache, A_wq, A_wo)
    g = _silu(_B_ref(xn, B_w_gate, B_w_up, B_w_down))
    return x + s * g
```

```asm
; @launch grid=(256,1,1) block=(512,1,1) lds=26368
.amdgcn_target "amdgcn-amd-amdhsa--gfx950"
.text
.globl recurrent_scan__mha_block_cached__swiglu_ffn__decode_kernel
.p2align 8
.type recurrent_scan__mha_block_cached__swiglu_ffn__decode_kernel,@function
recurrent_scan__mha_block_cached__swiglu_ffn__decode_kernel:
  s_cmp_ge_u32 s2, 256
  s_cbranch_scc1 L_end
  s_load_dwordx16 s[4:19], s[0:1], 0
  s_load_dwordx8 s[20:27], s[0:1], 64
  s_getpc_b64 s[80:81]
L_pc:
  v_cmp_le_u32 vcc, 384, v0
  v_subrev_u32 v8, 384, v0
  v_lshlrev_b32 v8, 7, v8
  v_min_u32 v8, L_end-L_pc, v8
  s_and_saveexec_b64 s[82:83], vcc
  s_cbranch_execz L_nopf
  global_load_dword v245, v8, s[80:81]
L_nopf:
  s_mov_b64 exec, s[82:83]
  v_and_b32 v1, 63, v0
  v_lshrrev_b32 v2, 6, v0
  s_nop 0
  v_readfirstlane_b32 s29, v2
  s_and_b32 s3, s2, 7
  s_lshr_b32 s84, s2, 3
  s_lshr_b32 s30, s84, 3
  s_lshl_b32 s80, s3, 2
  s_add_u32 s30, s30, s80
  s_and_b32 s31, s84, 7
  s_mul_i32 s72, s84, 205
  s_lshr_b32 s72, s72, 10
  s_mul_i32 s80, s72, 5
  s_sub_u32 s73, s84, s80
  s_lshr_b32 s74, s72, 1
  s_mul_i32 s80, s74, 10
  s_sub_u32 s75, s84, s80
  s_mul_i32 s80, s3, 6
  s_add_u32 s72, s72, s80
  s_mul_i32 s80, s3, 3
  s_add_u32 s74, s74, s80
  s_cmp_lt_u32 s84, 30
  s_cselect_b32 s91, -1, 0
  v_lshlrev_b32 v2, 4, v1
  v_lshlrev_b32 v3, 2, v1
  v_lshrrev_b32 v6, 3, v1
  v_and_b32 v7, 7, v1
  v_lshlrev_b32 v7, 4, v7
  s_and_b32 s80, s2, 7
  s_lshl_b32 s81, s80, 2
  s_lshr_b32 s90, 1162171990, s81
  s_and_b32 s90, s90, 15
  s_cmp_lt_u32 s80, 4
  s_mov_b32 s86, 606018326
  s_cselect_b32 s86, 285935104, s86
  s_and_b32 s80, s80, 3
  s_lshl_b32 s80, s80, 3
  s_lshr_b32 s86, s86, s80
  s_and_b32 s86, s86, 255
  s_lshl_b32 s86, s86, 4
  s_mul_i32 s81, s29, s90
  s_lshl_b32 s81, s81, 1
  s_add_u32 s86, s86, s81
  s_mul_i32 s80, s86, 12288
  v_lshrrev_b32 v8, 5, v1
  v_mul_u32_u24 v8, 12288, v8
  v_and_b32 v9, 31, v1
  v_mul_u32_u24 v9, 12, v9
  v_add3_u32 v4, v8, v9, s80
  s_lshl_b32 s82, s29, 6
  v_add_u32 v224, s82, v6
  v_mul_u32_u24 v224, 384, v224
  v_add_u32 v224, v224, v7
  s_lshl_b32 s82, s30, 3
  s_add_u32 s82, s82, s31
  s_mul_i32 s83, s82, 196608
  s_lshr_b32 s84, s2, 3
  s_mul_i32 s84, s84, 384
  s_mov_b32 s64, 0
  s_mov_b32 s65, 3072
  s_mov_b32 s66, 6144
  s_mov_b32 s67, 9216
  s_mov_b32 s68, 12288
  s_mov_b32 s69, 15360
  s_mov_b32 s70, 18432
  s_mov_b32 s71, 21504
  s_mov_b32 s43, 0x20000
  s_mov_b32 s38, 196608
  s_mov_b32 s39, 0x20000
  s_mov_b32 s34, 196608
  s_mov_b32 s35, 0x20000
  s_sub_u32 s42, 7864320, s84
  s_waitcnt lgkmcnt(0)
  s_cmp_lg_u32 s29, 0
  s_cbranch_scc1 L_xskip_1
  global_load_dwordx4 v[156:159], v2, s[4:5]
  global_load_dword v160, v3, s[4:5] offset:1024
L_xskip_1:
  s_add_u32 s40, s10, s84
  s_addc_u32 s41, s11, 0
  s_mov_b32 s80, 0x40000000
  s_cmp_gt_u32 s90, 1
  s_cselect_b32 s76, 24576, s80
  s_cmp_gt_u32 s90, 2
  s_cselect_b32 s77, 49152, s80
  s_cmp_gt_u32 s90, 3
  s_cselect_b32 s78, 73728, s80
  s_cmp_gt_u32 s90, 4
  s_cselect_b32 s79, 98304, s80
  s_cmp_gt_u32 s90, 5
  s_cselect_b32 s14, 122880, s80
  buffer_load_dwordx3 v[128:130], v4, s[40:43], 0 offen nt
  buffer_load_dwordx3 v[132:134], v4, s[40:43], s76 offen nt
  buffer_load_dwordx3 v[136:138], v4, s[40:43], s77 offen nt
  buffer_load_dwordx3 v[140:142], v4, s[40:43], s78 offen nt
  buffer_load_dwordx3 v[144:146], v4, s[40:43], s79 offen nt
  buffer_load_dwordx3 v[148:150], v4, s[40:43], s14 offen nt
  s_load_dword s28, s[26:27], 0
  s_add_u32 s32, s6, s83
  s_addc_u32 s33, s7, 0
  s_add_u32 s36, s8, s83
  s_addc_u32 s37, s9, 0
  s_mov_b32 s60, s26
  s_mov_b32 s61, s27
  s_mov_b32 s62, 1953792
  s_mov_b32 s63, 0x20000
  s_lshl_b32 s80, s74, 7
  s_add_u32 s48, s16, s80
  s_addc_u32 s49, s17, 0
  s_sub_u32 s50, 1966080, s80
  s_and_b32 s50, s50, s91
  s_mov_b32 s51, 0x20000
  s_add_u32 s52, s18, s80
  s_addc_u32 s53, s19, 0
  s_mov_b32 s54, s50
  s_mov_b32 s55, 0x20000
  s_lshl_b32 s80, s73, 8
  s_add_u32 s44, s12, s80
  s_addc_u32 s45, s13, 0
  s_sub_u32 s46, 7864320, s80
  s_and_b32 s46, s46, s91
  s_mov_b32 s47, 0x20000
  s_add_u32 s56, s20, s80
  s_addc_u32 s57, s21, 0
  s_sub_u32 s58, 1966080, s80
  s_and_b32 s58, s58, s91
  s_mov_b32 s59, 0x20000
  s_mov_b32 s79, 393216
  s_mov_b32 s88, 163840
  s_mov_b32 s89, 327680
  v_and_b32 v10, 7, v1
  v_lshrrev_b32 v11, 4, v1
  v_and_b32 v12, 15, v1
  s_lshl_b32 s80, s75, 6
  s_lshl_b32 s81, s29, 3
  s_add_u32 s80, s80, s81
  v_add_u32 v240, s80, v6
  v_mul_u32_u24 v239, 3072, v240
  v_add_u32 v239, v239, v7
  v_min_u32 v240, 639, v240
  v_lshlrev_b32 v240, 1, v240
  s_mul_i32 s80, s30, 768
  s_mul_i32 s81, s29, 12
  s_add_u32 s80, s80, s81
  s_lshl_b32 s80, s80, 4
  s_add_u32 s80, s80, 4096
  v_mul_u32_u24 v13, 1536, v10
  v_lshl_add_u32 v14, v6, 4, v13
  v_add_u32 v225, s80, v14
  v_and_b32 v14, 3, v6
  v_lshl_add_u32 v14, v14, 4, v13
  s_add_u32 s80, s80, 128
  v_add_u32 v226, s80, v14
  s_lshl_b32 s80, s30, 10
  s_add_u32 s80, s80, 643072
  v_lshl_add_u32 v228, v1, 4, s80
  s_lshl_b32 s81, s31, 3
  s_add_u32 s81, s81, s29
  s_lshl_b32 s81, s81, 4
  s_add_u32 s80, s80, s81
  v_mov_b32 v227, s80
  s_lshr_b32 s80, s72, 1
  s_mul_i32 s80, s80, 640
  s_and_b32 s81, s72, 1
  s_lshl_b32 s81, s81, 4
  s_add_u32 s80, s80, s81
  s_lshl_b32 s81, s29, 1
  s_add_u32 s80, s80, s81
  s_lshl_b32 s80, s80, 4
  s_add_u32 s80, s80, 397312
  v_min_u32 v13, 9, v12
  v_lshlrev_b32 v13, 6, v13
  v_lshrrev_b32 v14, 1, v11
  v_lshl_add_u32 v13, v14, 5, v13
  v_and_b32 v14, 1, v11
  v_add_u32 v13, v13, v14
  v_lshlrev_b32 v13, 4, v13
  v_add_u32 v229, s80, v13
  s_lshl_b32 s80, s72, 6
  s_lshl_b32 s81, s29, 3
  s_add_u32 s80, s80, s81
  s_lshl_b32 s80, s80, 4
  s_add_u32 s80, s80, 675840
  v_mul_u32_u24 v13, 49152, v10
  v_lshl_add_u32 v13, v6, 4, v13
  v_add_u32 v230, s80, v13
  s_lshl_b32 s80, s72, 7
  s_lshl_b32 s81, s29, 4
  s_add_u32 s80, s80, s81
  v_lshl_add_u32 v13, v11, 2, s80
  v_mul_u32_u24 v13, 1280, v13
  v_lshl_add_u32 v231, v12, 4, v13
  s_lshl_b32 s80, s72, 5
  s_lshl_b32 s81, s29, 2
  s_add_u32 s80, s80, s81
  v_and_b32 v13, 1, v11
  v_lshlrev_b32 v13, 1, v13
  v_lshrrev_b32 v14, 1, v11
  v_add3_u32 v13, v13, v14, s80
  v_mul_u32_u24 v13, 1280, v13
  v_lshl_add_u32 v232, v12, 4, v13
  s_min_u32 s80, s2, 159
  s_lshl_b32 s80, s80, 2
  v_and_b32 v13, 3, v1
  v_add_u32 v13, s80, v13
  v_lshlrev_b32 v234, 1, v13
  v_lshrrev_b32 v14, 2, v1
  v_mul_u32_u24 v14, 640, v14
  v_add_u32 v13, v13, v14
  v_lshlrev_b32 v13, 4, v13
  v_add_u32 v233, 1462272, v13
  s_mul_i32 s80, s29, 768
  v_and_b32 v13, 1, v11
  v_lshrrev_b32 v14, 1, v11
  v_lshlrev_b32 v15, 5, v10
  v_lshl_add_u32 v15, v13, 3, v15
  v_lshl_add_u32 v15, v14, 4, v15
  v_add_u32 v241, s80, v15
  s_lshl_b32 s80, s29, 10
  v_lshlrev_b32 v15, 5, v12
  v_lshl_add_u32 v15, v13, 4, v15
  v_lshl_add_u32 v15, v14, 9, v15
  v_add_u32 v242, s80, v15
  s_mul_i32 s80, s31, 3072
  s_mul_i32 s81, s30, 96
  s_add_u32 s80, s80, s81
  s_lshl_b32 s80, s80, 4
  s_add_u32 s80, s80, 675840
  v_lshl_add_u32 v243, v0, 4, s80
  s_mul_i32 s80, s72, 640
  s_lshl_b32 s81, s73, 7
  s_add_u32 s80, s80, s81
  s_lshl_b32 s80, s80, 4
  s_add_u32 s80, s80, 1462272
  v_lshl_add_u32 v244, v0, 4, s80
  buffer_load_dwordx4 v[32:35], v224, s[32:35], s64 offen offset:0 nt
  s_cmp_lg_u32 s29, 0
  s_cbranch_scc1 L_lnskip_2
  v_mov_b32 v8, 0
  v_mov_b32 v9, 0
  v_mov_b32 v10, 0
  v_mov_b32 v11, 0
  v_mov_b32 v12, 0
  ds_write_b128 v12, v[8:11] offset:26256
  s_waitcnt vmcnt(7)
  v_lshlrev_b32 v16, 16, v156
  v_and_b32 v17, 0xffff0000, v156
  v_lshlrev_b32 v18, 16, v157
  v_and_b32 v19, 0xffff0000, v157
  v_lshlrev_b32 v20, 16, v158
  v_and_b32 v21, 0xffff0000, v158
  v_lshlrev_b32 v22, 16, v159
  v_and_b32 v23, 0xffff0000, v159
  v_lshlrev_b32 v24, 16, v160
  v_and_b32 v25, 0xffff0000, v160
  v_add_f32 v26, v16, v17
  v_add_f32 v27, v18, v19
  v_add_f32 v26, v26, v20
  v_add_f32 v27, v27, v21
  v_add_f32 v26, v26, v22
  v_add_f32 v27, v27, v23
  v_add_f32 v26, v26, v24
  v_add_f32 v27, v27, v25
  v_add_f32 v26, v26, v27
  s_nop 1
  v_add_f32_dpp v26, v26, v26 quad_perm:[1,0,3,2] row_mask:0xf bank_mask:0xf
  s_nop 1
  v_add_f32_dpp v26, v26, v26 quad_perm:[2,3,0,1] row_mask:0xf bank_mask:0xf
  s_nop 1
  v_add_f32_dpp v26, v26, v26 row_half_mirror row_mask:0xf bank_mask:0xf
  s_nop 1
  v_add_f32_dpp v26, v26, v26 row_mirror row_mask:0xf bank_mask:0xf
  v_mov_b32 v27, v26
  s_nop 1
  v_permlane16_swap_b32 v26, v27
  v_add_f32 v26, v26, v27
  v_mov_b32 v27, v26
  s_nop 1
  v_permlane32_swap_b32 v26, v27
  v_add_f32 v26, v26, v27
  v_mul_f32 v26, 0x3acccccd, v26
  v_sub_f32 v28, v16, v26
  v_sub_f32 v29, v17, v26
  v_mul_f32 v27, v28, v28
  v_mul_f32 v30, v29, v29
  v_sub_f32 v28, v18, v26
  v_sub_f32 v29, v19, v26
  v_fmac_f32 v27, v28, v28
  v_fmac_f32 v30, v29, v29
  v_sub_f32 v28, v20, v26
  v_sub_f32 v29, v21, v26
  v_fmac_f32 v27, v28, v28
  v_fmac_f32 v30, v29, v29
  v_sub_f32 v28, v22, v26
  v_sub_f32 v29, v23, v26
  v_fmac_f32 v27, v28, v28
  v_fmac_f32 v30, v29, v29
  v_sub_f32 v28, v24, v26
  v_sub_f32 v29, v25, v26
  v_fmac_f32 v27, v28, v28
  v_fmac_f32 v30, v29, v29
  v_add_f32 v27, v27, v30
  s_nop 1
  v_add_f32_dpp v27, v27, v27 quad_perm:[1,0,3,2] row_mask:0xf bank_mask:0xf
  s_nop 1
  v_add_f32_dpp v27, v27, v27 quad_perm:[2,3,0,1] row_mask:0xf bank_mask:0xf
  s_nop 1
  v_add_f32_dpp v27, v27, v27 row_half_mirror row_mask:0xf bank_mask:0xf
  s_nop 1
  v_add_f32_dpp v27, v27, v27 row_mirror row_mask:0xf bank_mask:0xf
  v_mov_b32 v28, v27
  s_nop 1
  v_permlane16_swap_b32 v27, v28
  v_add_f32 v27, v27, v28
  v_mov_b32 v28, v27
  s_nop 1
  v_permlane32_swap_b32 v27, v28
  v_add_f32 v27, v27, v28
  v_mul_f32 v27, 0x3acccccd, v27
  v_cvt_pk_bf16_f32 v26, v26, v27
  v_and_b32 v27, 0xffff0000, v26
  v_lshlrev_b32 v26, 16, v26
  v_add_f32 v27, 0x3727c5ac, v27
  v_cvt_pk_bf16_f32 v27, v27, v27
  v_and_b32 v27, 0xffff0000, v27
  v_sqrt_f32 v27, v27
  s_nop 0
  v_cvt_pk_bf16_f32 v27, v27, v27
  v_and_b32 v27, 0xffff0000, v27
  v_rcp_f32 v28, v27
  v_sub_f32 v16, v16, v26
  v_sub_f32 v17, v17, v26
  v_sub_f32 v18, v18, v26
  v_sub_f32 v19, v19, v26
  v_sub_f32 v20, v20, v26
  v_sub_f32 v21, v21, v26
  v_sub_f32 v22, v22, v26
  v_sub_f32 v23, v23, v26
  v_sub_f32 v24, v24, v26
  v_sub_f32 v25, v25, v26
  v_cvt_pk_bf16_f32 v8, v16, v17
  v_cvt_pk_bf16_f32 v9, v18, v19
  v_cvt_pk_bf16_f32 v10, v20, v21
  v_cvt_pk_bf16_f32 v11, v22, v23
  v_cvt_pk_bf16_f32 v12, v24, v25
  v_lshlrev_b32 v16, 16, v8
  v_and_b32 v17, 0xffff0000, v8
  v_lshlrev_b32 v18, 16, v9
  v_and_b32 v19, 0xffff0000, v9
  v_lshlrev_b32 v20, 16, v10
  v_and_b32 v21, 0xffff0000, v10
  v_lshlrev_b32 v22, 16, v11
  v_and_b32 v23, 0xffff0000, v11
  v_lshlrev_b32 v24, 16, v12
  v_and_b32 v25, 0xffff0000, v12
  v_mul_f32 v200, v16, v28
  v_mul_f32 v201, v17, v28
  v_mul_f32 v202, v18, v28
  v_mul_f32 v203, v19, v28
  v_mul_f32 v204, v20, v28
  v_mul_f32 v205, v21, v28
  v_mul_f32 v206, v22, v28
  v_mul_f32 v207, v23, v28
  v_mul_f32 v208, v24, v28
  v_mul_f32 v209, v25, v28
  v_fma_f32 v16, -v200, v27, v16
  v_fma_f32 v17, -v201, v27, v17
  v_fma_f32 v18, -v202, v27, v18
  v_fma_f32 v19, -v203, v27, v19
  v_fma_f32 v20, -v204, v27, v20
  v_fma_f32 v21, -v205, v27, v21
  v_fma_f32 v22, -v206, v27, v22
  v_fma_f32 v23, -v207, v27, v23
  v_fma_f32 v24, -v208, v27, v24
  v_fma_f32 v25, -v209, v27, v25
  v_fma_f32 v16, v16, v28, v200
  v_fma_f32 v17, v17, v28, v201
  v_fma_f32 v18, v18, v28, v202
  v_fma_f32 v19, v19, v28, v203
  v_fma_f32 v20, v20, v28, v204
  v_fma_f32 v21, v21, v28, v205
  v_fma_f32 v22, v22, v28, v206
  v_fma_f32 v23, v23, v28, v207
  v_fma_f32 v24, v24, v28, v208
  v_fma_f32 v25, v25, v28, v209
  v_cvt_pk_bf16_f32 v8, v16, v17
  v_cvt_pk_bf16_f32 v9, v18, v19
  v_cvt_pk_bf16_f32 v10, v20, v21
  v_cvt_pk_bf16_f32 v11, v22, v23
  v_cvt_pk_bf16_f32 v12, v24, v25
  ds_write_b128 v2, v[8:11] offset:0
  ds_write_b32 v3, v12 offset:1024
L_lnskip_2:
  s_waitcnt lgkmcnt(0)
  s_barrier
  v_lshrrev_b32 v13, 5, v1
  v_add_u32 v13, s86, v13
  v_lshlrev_b32 v13, 1, v13
  s_waitcnt lgkmcnt(0)
  s_add_u32 s28, s28, 1
  ds_read_u16 v16, v13 offset:0
  ds_read_u16 v17, v13 offset:4
  ds_read_u16 v18, v13 offset:8
  ds_read_u16 v19, v13 offset:12
  ds_read_u16 v20, v13 offset:16
  ds_read_u16 v21, v13 offset:20
  ds_read_u16 v240, v240 offset:0
  v_mov_b32 v200, 0
  v_mov_b32 v201, 0
  v_mov_b32 v202, 0
  v_mov_b32 v203, 0
  v_mov_b32 v204, 0
  v_mov_b32 v205, 0
  s_mul_i32 s80, s29, 768
  v_and_b32 v13, 31, v1
  v_mul_u32_u24 v13, 6, v13
  v_lshrrev_b32 v14, 5, v1
  v_add_u32 v13, v13, v14
  v_lshl_add_u32 v13, v13, 2, s80
  s_waitcnt lgkmcnt(0)
  s_cmp_gt_u32 s90, 4
  s_cselect_b32 s80, -1, 0
  v_and_b32 v20, s80, v20
  s_cmp_gt_u32 s90, 5
  s_cselect_b32 s80, -1, 0
  v_and_b32 v21, s80, v21
  v_lshlrev_b32 v208, 16, v16
  v_lshlrev_b32 v209, 16, v17
  v_lshlrev_b32 v210, 16, v18
  v_lshlrev_b32 v211, 16, v19
  v_lshlrev_b32 v212, 16, v20
  v_lshlrev_b32 v213, 16, v21
  s_waitcnt vmcnt(4)
  buffer_load_dwordx4 v[36:39], v224, s[32:35], s64 offen offset:128 nt
  s_waitcnt vmcnt(4)
  buffer_load_dwordx4 v[40:43], v224, s[32:35], s64 offen offset:256 nt
  s_waitcnt vmcnt(4)
  buffer_load_dwordx4 v[44:47], v224, s[32:35], s65 offen offset:0 nt
  s_waitcnt vmcnt(4)
  buffer_load_dwordx4 v[48:51], v224, s[32:35], s65 offen offset:128 nt
  v_dot2c_f32_bf16 v200, v128, v16
  v_dot2c_f32_bf16 v201, v128, v208
  v_dot2c_f32_bf16 v202, v129, v16
  v_dot2c_f32_bf16 v203, v129, v208
  v_dot2c_f32_bf16 v204, v130, v16
  v_dot2c_f32_bf16 v205, v130, v208
  v_dot2c_f32_bf16 v200, v132, v17
  v_dot2c_f32_bf16 v201, v132, v209
  v_dot2c_f32_bf16 v202, v133, v17
  v_dot2c_f32_bf16 v203, v133, v209
  v_dot2c_f32_bf16 v204, v134, v17
  v_dot2c_f32_bf16 v205, v134, v209
  v_dot2c_f32_bf16 v200, v136, v18
  v_dot2c_f32_bf16 v201, v136, v210
  v_dot2c_f32_bf16 v202, v137, v18
  v_dot2c_f32_bf16 v203, v137, v210
  v_dot2c_f32_bf16 v204, v138, v18
  v_dot2c_f32_bf16 v205, v138, v210
  v_dot2c_f32_bf16 v200, v140, v19
  v_dot2c_f32_bf16 v201, v140, v211
  v_dot2c_f32_bf16 v202, v141, v19
  v_dot2c_f32_bf16 v203, v141, v211
  v_dot2c_f32_bf16 v204, v142, v19
  v_dot2c_f32_bf16 v205, v142, v211
  v_dot2c_f32_bf16 v200, v144, v20
  v_dot2c_f32_bf16 v201, v144, v212
  v_dot2c_f32_bf16 v202, v145, v20
  v_dot2c_f32_bf16 v203, v145, v212
  v_dot2c_f32_bf16 v204, v146, v20
  v_dot2c_f32_bf16 v205, v146, v212
  v_dot2c_f32_bf16 v200, v148, v21
  v_dot2c_f32_bf16 v201, v148, v213
  v_dot2c_f32_bf16 v202, v149, v21
  v_dot2c_f32_bf16 v203, v149, v213
  v_dot2c_f32_bf16 v204, v150, v21
  v_dot2c_f32_bf16 v205, v150, v213
  v_permlane32_swap_b32 v200, v201
  v_permlane32_swap_b32 v202, v203
  s_nop 0
  v_permlane32_swap_b32 v204, v205
  v_add_f32 v200, v200, v201
  v_add_f32 v202, v202, v203
  v_add_f32 v204, v204, v205
  ds_write_b32 v13, v200 offset:1280
  ds_write_b32 v13, v202 offset:1288
  ds_write_b32 v13, v204 offset:1296
  s_waitcnt lgkmcnt(0)
  v_mov_b32 v30, 0
  v_mov_b32 v31, 1
  s_mov_b64 exec, 1
  ds_add_rtn_u32 v31, v30, v31 offset:26256
  s_waitcnt lgkmcnt(0)
  s_mov_b64 exec, -1
  v_readfirstlane_b32 s80, v31
  s_cmp_eq_u32 s80, 7
  s_cbranch_scc0 L_pub1_3
  s_mov_b32 s80, s2
  s_nop 0
  s_mul_i32 s80, s80, 1536
  s_add_u32 s80, s80, 4096
  v_lshlrev_b32 v28, 3, v1
  v_lshl_add_u32 v18, v1, 4, s80
  v_mov_b32 v21, s28
  v_mov_b32 v23, s28
  ds_read_b64 v[2:3], v28 offset:1280
  ds_read_b64 v[4:5], v28 offset:2048
  ds_read_b64 v[6:7], v28 offset:2816
  ds_read_b64 v[8:9], v28 offset:3584
  ds_read_b64 v[10:11], v28 offset:4352
  ds_read_b64 v[12:13], v28 offset:5120
  ds_read_b64 v[14:15], v28 offset:5888
  ds_read_b64 v[16:17], v28 offset:6656
  s_waitcnt lgkmcnt(0)
  v_add_f32 v2, v2, v4
  v_add_f32 v6, v6, v8
  v_add_f32 v10, v10, v12
  v_add_f32 v14, v14, v16
  v_add_f32 v2, v2, v6
  v_add_f32 v10, v10, v14
  v_add_f32 v20, v2, v10
  v_add_f32 v3, v3, v5
  v_add_f32 v7, v7, v9
  v_add_f32 v11, v11, v13
  v_add_f32 v15, v15, v17
  v_add_f32 v3, v3, v7
  v_add_f32 v11, v11, v15
  v_add_f32 v22, v3, v11
  buffer_store_dwordx4 v[20:23], v18, s[60:63], 0 offen offset:0 sc1
  s_mov_b64 exec, 0xffffffff
  ds_read_b64 v[2:3], v28 offset:1792
  ds_read_b64 v[4:5], v28 offset:2560
  ds_read_b64 v[6:7], v28 offset:3328
  ds_read_b64 v[8:9], v28 offset:4096
  ds_read_b64 v[10:11], v28 offset:4864
  ds_read_b64 v[12:13], v28 offset:5632
  ds_read_b64 v[14:15], v28 offset:6400
  ds_read_b64 v[16:17], v28 offset:7168
  s_waitcnt lgkmcnt(0)
  v_add_f32 v2, v2, v4
  v_add_f32 v6, v6, v8
  v_add_f32 v10, v10, v12
  v_add_f32 v14, v14, v16
  v_add_f32 v2, v2, v6
  v_add_f32 v10, v10, v14
  v_add_f32 v20, v2, v10
  v_add_f32 v3, v3, v5
  v_add_f32 v7, v7, v9
  v_add_f32 v11, v11, v13
  v_add_f32 v15, v15, v17
  v_add_f32 v3, v3, v7
  v_add_f32 v11, v11, v15
  v_add_f32 v22, v3, v11
  buffer_store_dwordx4 v[20:23], v18, s[60:63], 0 offen offset:1024 sc1
  s_mov_b64 exec, -1
L_pub1_3:
  s_waitcnt vmcnt(4)
  buffer_load_dwordx4 v[52:55], v224, s[32:35], s65 offen offset:256 nt
  s_waitcnt vmcnt(4)
  buffer_load_dwordx4 v[116:119], v239, s[48:51], 0 offen nt
  s_waitcnt vmcnt(4)
  buffer_load_dwordx4 v[120:123], v239, s[52:55], 0 offen nt
  s_waitcnt vmcnt(4)
  buffer_load_dwordx4 v[56:59], v224, s[32:35], s66 offen offset:0 nt
  s_waitcnt vmcnt(4)
  buffer_load_dwordx4 v[60:63], v224, s[32:35], s66 offen offset:128 nt
  s_waitcnt vmcnt(4)
  buffer_load_dwordx4 v[64:67], v224, s[32:35], s66 offen offset:256 nt
  s_waitcnt vmcnt(4)
  buffer_load_dwordx4 v[68:71], v224, s[32:35], s67 offen offset:0 nt
  s_waitcnt vmcnt(4)
  buffer_load_dwordx4 v[72:75], v224, s[32:35], s67 offen offset:128 nt
  v_lshlrev_b32 v2, 16, v240
  v_mov_b32 v208, 0
  v_mov_b32 v209, 0
  v_mov_b32 v210, 0
  v_mov_b32 v211, 0
  v_mov_b32 v212, 0
  v_mov_b32 v213, 0
  v_mov_b32 v214, 0
  v_mov_b32 v215, 0
  v_mov_b32 v216, 0
  v_mov_b32 v217, 0
  v_mov_b32 v218, 0
  v_mov_b32 v219, 0
  v_mov_b32 v220, 0
  v_mov_b32 v221, 0
  v_mov_b32 v222, 0
  v_mov_b32 v223, 0
  v_dot2c_f32_bf16 v208, v116, v240
  v_dot2c_f32_bf16 v209, v116, v2
  v_dot2c_f32_bf16 v216, v120, v240
  v_dot2c_f32_bf16 v217, v120, v2
  v_dot2c_f32_bf16 v210, v117, v240
  v_dot2c_f32_bf16 v211, v117, v2
  v_dot2c_f32_bf16 v218, v121, v240
  v_dot2c_f32_bf16 v219, v121, v2
  v_dot2c_f32_bf16 v212, v118, v240
  v_dot2c_f32_bf16 v213, v118, v2
  v_dot2c_f32_bf16 v220, v122, v240
  v_dot2c_f32_bf16 v221, v122, v2
  v_dot2c_f32_bf16 v214, v119, v240
  v_dot2c_f32_bf16 v215, v119, v2
  v_dot2c_f32_bf16 v222, v123, v240
  v_dot2c_f32_bf16 v223, v123, v2
  v_permlane32_swap_b32 v208, v216
  v_permlane32_swap_b32 v209, v217
  v_permlane32_swap_b32 v210, v218
  v_permlane32_swap_b32 v211, v219
  v_permlane32_swap_b32 v212, v220
  v_permlane32_swap_b32 v213, v221
  v_permlane32_swap_b32 v214, v222
  v_permlane32_swap_b32 v215, v223
  v_add_f32 v208, v208, v216
  v_add_f32 v209, v209, v217
  v_add_f32 v210, v210, v218
  v_add_f32 v211, v211, v219
  v_add_f32 v212, v212, v220
  v_add_f32 v213, v213, v221
  v_add_f32 v214, v214, v222
  v_add_f32 v215, v215, v223
  v_permlane16_swap_b32 v208, v212
  v_permlane16_swap_b32 v209, v213
  v_permlane16_swap_b32 v210, v214
  v_permlane16_swap_b32 v211, v215
  v_add_f32 v208, v208, v212
  v_add_f32 v209, v209, v213
  v_add_f32 v210, v210, v214
  v_add_f32 v211, v211, v215
  v_add_f32_dpp v208, v208, v208 row_ror:8 row_mask:0xf bank_mask:0xf
  v_add_f32_dpp v209, v209, v209 row_ror:8 row_mask:0xf bank_mask:0xf
  v_add_f32_dpp v210, v210, v210 row_ror:8 row_mask:0xf bank_mask:0xf
  v_add_f32_dpp v211, v211, v211 row_ror:8 row_mask:0xf bank_mask:0xf
  s_lshl_b32 s80, s29, 9
  v_lshrrev_b32 v13, 5, v1
  v_lshlrev_b32 v13, 8, v13
  v_lshrrev_b32 v14, 4, v1
  v_and_b32 v14, 1, v14
  v_lshl_add_u32 v13, v14, 4, v13
  v_and_b32 v14, 7, v1
  v_lshl_add_u32 v13, v14, 5, v13
  v_add_u32 v13, s80, v13
  ds_write_b128 v13, v[208:211] offset:7424
  s_waitcnt vmcnt(4)
  buffer_load_dwordx4 v[76:79], v224, s[32:35], s67 offen offset:256 nt
  s_waitcnt vmcnt(4)
  buffer_load_dwordx4 v[80:83], v224, s[32:35], s68 offen offset:0 nt
  s_waitcnt vmcnt(4)
  buffer_load_dwordx4 v[84:87], v224, s[32:35], s68 offen offset:128 nt
  s_waitcnt vmcnt(4)
  buffer_load_dwordx4 v[88:91], v224, s[32:35], s68 offen offset:256 nt
  s_waitcnt vmcnt(4)
  buffer_load_dwordx4 v[246:249], v225, s[60:63], 0 offen sc1
  s_waitcnt vmcnt(4)
  buffer_load_dwordx4 v[250:253], v226, s[60:63], 0 offen sc1
  s_waitcnt vmcnt(4)
  buffer_load_dwordx4 v[92:95], v224, s[32:35], s69 offen offset:0 nt
  s_waitcnt vmcnt(4)
  buffer_load_dwordx4 v[96:99], v224, s[32:35], s69 offen offset:128 nt
  s_waitcnt vmcnt(4)
  buffer_load_dwordx4 v[100:103], v224, s[32:35], s69 offen offset:256 nt
  s_waitcnt vmcnt(4)
  buffer_load_dwordx4 v[104:107], v224, s[32:35], s70 offen offset:0 nt
  s_waitcnt vmcnt(4)
  buffer_load_dwordx4 v[108:111], v224, s[32:35], s70 offen offset:128 nt
  v_cmp_ne_u32 vcc, s28, v247
  v_cmp_ne_u32 s[80:81], s28, v249
  s_or_b64 vcc, vcc, s[80:81]
  v_cmp_ne_u32 s[80:81], s28, v251
  s_or_b64 vcc, vcc, s[80:81]
  v_cmp_ne_u32 s[80:81], s28, v253
  s_or_b64 vcc, vcc, s[80:81]
  s_cmp_eq_u64 vcc, 0
  s_cbranch_scc1 Lp_done_4
  s_mov_b32 s90, 0
  s_mov_b64 s[82:83], exec
Lp_loop_5:
  s_mov_b64 exec, vcc
  s_sleep 2
  buffer_load_dwordx4 v[246:249], v225, s[60:63], 0 offen sc1
  buffer_load_dwordx4 v[250:253], v226, s[60:63], 0 offen sc1
  s_waitcnt vmcnt(0)
  v_cmp_ne_u32 vcc, s28, v247
  v_cmp_ne_u32 s[80:81], s28, v249
  s_or_b64 vcc, vcc, s[80:81]
  v_cmp_ne_u32 s[80:81], s28, v251
  s_or_b64 vcc, vcc, s[80:81]
  v_cmp_ne_u32 s[80:81], s28, v253
  s_or_b64 vcc, vcc, s[80:81]
  s_mov_b64 exec, s[82:83]
  s_add_u32 s90, s90, 1
  s_cmp_ge_u32 s90, 200000
  s_cbranch_scc1 Lp_done_4
  s_cmp_eq_u64 vcc, 0
  s_cbranch_scc0 Lp_loop_5
Lp_done_4:
  s_nop 1
  v_add_f32_dpp v246, v246, v246 quad_perm:[1,0,3,2] row_mask:0xf bank_mask:0xf
  v_add_f32_dpp v248, v248, v248 quad_perm:[1,0,3,2] row_mask:0xf bank_mask:0xf
  v_add_f32_dpp v250, v250, v250 quad_perm:[1,0,3,2] row_mask:0xf bank_mask:0xf
  v_add_f32_dpp v252, v252, v252 quad_perm:[1,0,3,2] row_mask:0xf bank_mask:0xf
  v_add_f32_dpp v246, v246, v246 quad_perm:[2,3,0,1] row_mask:0xf bank_mask:0xf
  v_add_f32_dpp v248, v248, v248 quad_perm:[2,3,0,1] row_mask:0xf bank_mask:0xf
  v_add_f32_dpp v250, v250, v250 quad_perm:[2,3,0,1] row_mask:0xf bank_mask:0xf
  v_add_f32_dpp v252, v252, v252 quad_perm:[2,3,0,1] row_mask:0xf bank_mask:0xf
  v_add_f32_dpp v246, v246, v246 row_half_mirror row_mask:0xf bank_mask:0xf
  v_add_f32_dpp v248, v248, v248 row_half_mirror row_mask:0xf bank_mask:0xf
  v_add_f32_dpp v250, v250, v250 row_half_mirror row_mask:0xf bank_mask:0xf
  v_add_f32_dpp v252, v252, v252 row_half_mirror row_mask:0xf bank_mask:0xf
  v_cvt_pk_bf16_f32 v246, v246, v248
  v_cvt_pk_bf16_f32 v250, v250, v252
  s_mul_i32 s80, s29, 48
  v_lshrrev_b32 v10, 3, v1
  v_lshl_add_u32 v11, v10, 2, s80
  v_and_b32 v10, 3, v10
  v_lshl_add_u32 v12, v10, 2, s80
  ds_write_b32 v11, v246 offset:11520
  ds_write_b32 v12, v250 offset:11552
  s_waitcnt lgkmcnt(0)
  s_barrier
  v_and_b32 v10, 7, v1
  v_lshlrev_b32 v10, 4, v10
  s_cmp_lt_u32 s29, 4
  s_cbranch_scc1 L_pr_6
  s_setprio 1
L_pr_6:
  ds_read_b128 v[164:167], v10 offset:11520
  ds_read_b128 v[168:171], v10 offset:11648
  ds_read_b128 v[172:175], v10 offset:11776
  s_cmp_lg_u32 s29, 2
  s_cbranch_scc1 L_pubg_7
  s_cmp_eq_u32 s91, 0
  s_cbranch_scc1 L_pubg_7
  v_lshlrev_b32 v28, 3, v1
  ds_read_b64 v[2:3], v28 offset:7424
  ds_read_b64 v[4:5], v28 offset:7936
  ds_read_b64 v[6:7], v28 offset:8448
  ds_read_b64 v[8:9], v28 offset:8960
  ds_read_b64 v[10:11], v28 offset:9472
  ds_read_b64 v[12:13], v28 offset:9984
  ds_read_b64 v[14:15], v28 offset:10496
  ds_read_b64 v[16:17], v28 offset:11008
  s_mul_i32 s80, s74, 10
  s_add_u32 s80, s80, s75
  s_lshl_b32 s80, s80, 10
  s_add_u32 s80, s80, 397312
  v_lshl_add_u32 v18, v1, 4, s80
  v_mov_b32 v21, s28
  v_mov_b32 v23, s28
  s_waitcnt lgkmcnt(0)
  v_add_f32 v2, v2, v4
  v_add_f32 v6, v6, v8
  v_add_f32 v10, v10, v12
  v_add_f32 v14, v14, v16
  v_add_f32 v2, v2, v6
  v_add_f32 v10, v10, v14
  v_add_f32 v20, v2, v10
  v_add_f32 v3, v3, v5
  v_add_f32 v7, v7, v9
  v_add_f32 v11, v11, v13
  v_add_f32 v15, v15, v17
  v_add_f32 v3, v3, v7
  v_add_f32 v11, v11, v15
  v_add_f32 v22, v3, v11
  buffer_store_dwordx4 v[20:23], v18, s[60:63], 0 offen sc1
L_pubg_7:
  v_mov_b32 v192, 0
  v_mov_b32 v193, 0
  v_mov_b32 v194, 0
  v_mov_b32 v195, 0
  v_mov_b32 v196, 0
  v_mov_b32 v197, 0
  v_mov_b32 v198, 0
  v_mov_b32 v199, 0
  s_waitcnt lgkmcnt(0)
  v_dot2c_f32_bf16 v192, v32, v164
  v_dot2c_f32_bf16 v193, v44, v164
  v_dot2c_f32_bf16 v192, v33, v165
  v_dot2c_f32_bf16 v193, v45, v165
  v_dot2c_f32_bf16 v192, v34, v166
  v_dot2c_f32_bf16 v193, v46, v166
  v_dot2c_f32_bf16 v192, v35, v167
  v_dot2c_f32_bf16 v193, v47, v167
  v_dot2c_f32_bf16 v192, v36, v168
  v_dot2c_f32_bf16 v193, v48, v168
  v_dot2c_f32_bf16 v192, v37, v169
  v_dot2c_f32_bf16 v193, v49, v169
  v_dot2c_f32_bf16 v192, v38, v170
  v_dot2c_f32_bf16 v193, v50, v170
  v_dot2c_f32_bf16 v192, v39, v171
  v_dot2c_f32_bf16 v193, v51, v171
  v_dot2c_f32_bf16 v192, v40, v172
  v_dot2c_f32_bf16 v193, v52, v172
  v_dot2c_f32_bf16 v192, v41, v173
  v_dot2c_f32_bf16 v193, v53, v173
  v_dot2c_f32_bf16 v192, v42, v174
  v_dot2c_f32_bf16 v193, v54, v174
  v_dot2c_f32_bf16 v192, v43, v175
  v_dot2c_f32_bf16 v193, v55, v175
  v_dot2c_f32_bf16 v194, v56, v164
  v_dot2c_f32_bf16 v195, v68, v164
  v_dot2c_f32_bf16 v194, v57, v165
  v_dot2c_f32_bf16 v195, v69, v165
  v_dot2c_f32_bf16 v194, v58, v166
  v_dot2c_f32_bf16 v195, v70, v166
  v_dot2c_f32_bf16 v194, v59, v167
  v_dot2c_f32_bf16 v195, v71, v167
  v_dot2c_f32_bf16 v194, v60, v168
  v_dot2c_f32_bf16 v195, v72, v168
  v_dot2c_f32_bf16 v194, v61, v169
  v_dot2c_f32_bf16 v195, v73, v169
  v_dot2c_f32_bf16 v194, v62, v170
  v_dot2c_f32_bf16 v195, v74, v170
  v_dot2c_f32_bf16 v194, v63, v171
  v_dot2c_f32_bf16 v195, v75, v171
  v_dot2c_f32_bf16 v194, v64, v172
  v_dot2c_f32_bf16 v195, v76, v172
  v_dot2c_f32_bf16 v194, v65, v173
  v_dot2c_f32_bf16 v195, v77, v173
  v_dot2c_f32_bf16 v194, v66, v174
  v_dot2c_f32_bf16 v195, v78, v174
  v_dot2c_f32_bf16 v194, v67, v175
  v_dot2c_f32_bf16 v195, v79, v175
  s_waitcnt vmcnt(4)
  buffer_load_dwordx4 v[112:115], v224, s[32:35], s70 offen offset:256 nt
  s_waitcnt vmcnt(4)
  buffer_load_dwordx4 v[116:119], v224, s[32:35], s71 offen offset:0 nt
  s_waitcnt vmcnt(4)
  buffer_load_dwordx4 v[120:123], v224, s[32:35], s71 offen offset:128 nt
  v_dot2c_f32_bf16 v196, v80, v164
  v_dot2c_f32_bf16 v197, v92, v164
  v_dot2c_f32_bf16 v196, v81, v165
  v_dot2c_f32_bf16 v197, v93, v165
  v_dot2c_f32_bf16 v196, v82, v166
  v_dot2c_f32_bf16 v197, v94, v166
  v_dot2c_f32_bf16 v196, v83, v167
  v_dot2c_f32_bf16 v197, v95, v167
  v_dot2c_f32_bf16 v196, v84, v168
  v_dot2c_f32_bf16 v197, v96, v168
  v_dot2c_f32_bf16 v196, v85, v169
  v_dot2c_f32_bf16 v197, v97, v169
  v_dot2c_f32_bf16 v196, v86, v170
  v_dot2c_f32_bf16 v197, v98, v170
  v_dot2c_f32_bf16 v196, v87, v171
  v_dot2c_f32_bf16 v197, v99, v171
  v_dot2c_f32_bf16 v196, v88, v172
  v_dot2c_f32_bf16 v197, v100, v172
  v_dot2c_f32_bf16 v196, v89, v173
  v_dot2c_f32_bf16 v197, v101, v173
  v_dot2c_f32_bf16 v196, v90, v174
  v_dot2c_f32_bf16 v197, v102, v174
  v_dot2c_f32_bf16 v196, v91, v175
  v_dot2c_f32_bf16 v197, v103, v175
  s_waitcnt vmcnt(4)
  buffer_load_dwordx4 v[124:127], v224, s[32:35], s71 offen offset:256 nt
  s_waitcnt vmcnt(4)
  buffer_load_dwordx4 v[128:131], v224, s[36:39], s64 offen offset:0 nt
  s_waitcnt vmcnt(4)
  buffer_load_dwordx4 v[132:135], v224, s[36:39], s64 offen offset:128 nt
  s_waitcnt vmcnt(4)
  buffer_load_dwordx4 v[136:139], v224, s[36:39], s64 offen offset:256 nt
  s_waitcnt vmcnt(4)
  buffer_load_dwordx4 v[140:143], v224, s[36:39], s65 offen offset:0 nt
  s_waitcnt vmcnt(4)
  buffer_load_dwordx4 v[144:147], v224, s[36:39], s65 offen offset:128 nt
  v_dot2c_f32_bf16 v198, v104, v164
  v_dot2c_f32_bf16 v199, v116, v164
  v_dot2c_f32_bf16 v198, v105, v165
  v_dot2c_f32_bf16 v199, v117, v165
  v_dot2c_f32_bf16 v198, v106, v166
  v_dot2c_f32_bf16 v199, v118, v166
  v_dot2c_f32_bf16 v198, v107, v167
  v_dot2c_f32_bf16 v199, v119, v167
  v_dot2c_f32_bf16 v198, v108, v168
  v_dot2c_f32_bf16 v199, v120, v168
  v_dot2c_f32_bf16 v198, v109, v169
  v_dot2c_f32_bf16 v199, v121, v169
  v_dot2c_f32_bf16 v198, v110, v170
  v_dot2c_f32_bf16 v199, v122, v170
  v_dot2c_f32_bf16 v198, v111, v171
  v_dot2c_f32_bf16 v199, v123, v171
  v_dot2c_f32_bf16 v198, v112, v172
  v_dot2c_f32_bf16 v199, v124, v172
  v_dot2c_f32_bf16 v198, v113, v173
  v_dot2c_f32_bf16 v199, v125, v173
  v_dot2c_f32_bf16 v198, v114, v174
  v_dot2c_f32_bf16 v199, v126, v174
  v_dot2c_f32_bf16 v198, v115, v175
  v_dot2c_f32_bf16 v199, v127, v175
  v_add_f32_dpp v192, v192, v192 quad_perm:[1,0,3,2] row_mask:0xf bank_mask:0xf
  v_add_f32_dpp v193, v193, v193 quad_perm:[1,0,3,2] row_mask:0xf bank_mask:0xf
  v_add_f32_dpp v194, v194, v194 quad_perm:[1,0,3,2] row_mask:0xf bank_mask:0xf
  v_add_f32_dpp v195, v195, v195 quad_perm:[1,0,3,2] row_mask:0xf bank_mask:0xf
  v_add_f32_dpp v196, v196, v196 quad_perm:[1,0,3,2] row_mask:0xf bank_mask:0xf
  v_add_f32_dpp v197, v197, v197 quad_perm:[1,0,3,2] row_mask:0xf bank_mask:0xf
  v_add_f32_dpp v198, v198, v198 quad_perm:[1,0,3,2] row_mask:0xf bank_mask:0xf
  v_add_f32_dpp v199, v199, v199 quad_perm:[1,0,3,2] row_mask:0xf bank_mask:0xf
  v_add_f32_dpp v192, v192, v192 quad_perm:[2,3,0,1] row_mask:0xf bank_mask:0xf
  v_add_f32_dpp v193, v193, v193 quad_perm:[2,3,0,1] row_mask:0xf bank_mask:0xf
  v_add_f32_dpp v194, v194, v194 quad_perm:[2,3,0,1] row_mask:0xf bank_mask:0xf
  v_add_f32_dpp v195, v195, v195 quad_perm:[2,3,0,1] row_mask:0xf bank_mask:0xf
  v_add_f32_dpp v196, v196, v196 quad_perm:[2,3,0,1] row_mask:0xf bank_mask:0xf
  v_add_f32_dpp v197, v197, v197 quad_perm:[2,3,0,1] row_mask:0xf bank_mask:0xf
  v_add_f32_dpp v198, v198, v198 quad_perm:[2,3,0,1] row_mask:0xf bank_mask:0xf
  v_add_f32_dpp v199, v199, v199 quad_perm:[2,3,0,1] row_mask:0xf bank_mask:0xf
  v_add_f32_dpp v192, v192, v192 row_half_mirror row_mask:0xf bank_mask:0xf
  v_add_f32_dpp v193, v193, v193 row_half_mirror row_mask:0xf bank_mask:0xf
  v_add_f32_dpp v194, v194, v194 row_half_mirror row_mask:0xf bank_mask:0xf
  v_add_f32_dpp v195, v195, v195 row_half_mirror row_mask:0xf bank_mask:0xf
  v_add_f32_dpp v196, v196, v196 row_half_mirror row_mask:0xf bank_mask:0xf
  v_add_f32_dpp v197, v197, v197 row_half_mirror row_mask:0xf bank_mask:0xf
  v_add_f32_dpp v198, v198, v198 row_half_mirror row_mask:0xf bank_mask:0xf
  v_add_f32_dpp v199, v199, v199 row_half_mirror row_mask:0xf bank_mask:0xf
  v_cvt_pk_bf16_f32 v2, v192, v193
  v_cvt_pk_bf16_f32 v3, v194, v195
  v_cvt_pk_bf16_f32 v4, v196, v197
  v_cvt_pk_bf16_f32 v5, v198, v199
  v_lshlrev_b32 v192, 16, v2
  v_and_b32 v193, 0xffff0000, v2
  v_lshlrev_b32 v194, 16, v3
  v_and_b32 v195, 0xffff0000, v3
  v_lshlrev_b32 v196, 16, v4
  v_and_b32 v197, 0xffff0000, v4
  v_lshlrev_b32 v198, 16, v5
  v_and_b32 v199, 0xffff0000, v5
  v_mul_f32 v192, 0x3d93cd3a, v192
  v_mul_f32 v193, 0x3d93cd3a, v193
  v_mul_f32 v194, 0x3d93cd3a, v194
  v_mul_f32 v195, 0x3d93cd3a, v195
  v_mul_f32 v196, 0x3d93cd3a, v196
  v_mul_f32 v197, 0x3d93cd3a, v197
  v_mul_f32 v198, 0x3d93cd3a, v198
  v_mul_f32 v199, 0x3d93cd3a, v199
  v_cvt_pk_bf16_f32 v2, v192, v193
  v_cvt_pk_bf16_f32 v3, v194, v195
  v_cvt_pk_bf16_f32 v4, v196, v197
  v_cvt_pk_bf16_f32 v5, v198, v199
  v_lshlrev_b32 v192, 16, v2
  v_and_b32 v193, 0xffff0000, v2
  v_lshlrev_b32 v194, 16, v3
  v_and_b32 v195, 0xffff0000, v3
  v_lshlrev_b32 v196, 16, v4
  v_and_b32 v197, 0xffff0000, v4
  v_lshlrev_b32 v198, 16, v5
  v_and_b32 v199, 0xffff0000, v5
  v_max3_f32 v235, v192, v193, v194
  v_max3_f32 v2, v195, v196, v197
  v_max3_f32 v235, v235, v198, v199
  v_max_f32 v235, v235, v2
  s_nop 1
  v_max_f32_dpp v235, v235, v235 row_ror:8 row_mask:0xf bank_mask:0xf
  v_mov_b32 v2, v235
  s_nop 1
  v_permlane16_swap_b32 v235, v2
  v_max_f32 v235, v235, v2
  v_mov_b32 v2, v235
  s_nop 1
  v_permlane32_swap_b32 v235, v2
  v_max_f32 v235, v235, v2
  v_sub_f32 v192, v192, v235
  v_sub_f32 v193, v193, v235
  v_sub_f32 v194, v194, v235
  v_sub_f32 v195, v195, v235
  v_sub_f32 v196, v196, v235
  v_sub_f32 v197, v197, v235
  v_sub_f32 v198, v198, v235
  v_sub_f32 v199, v199, v235
  v_mul_f32 v192, 0x3fb8aa3b, v192
  v_mul_f32 v193, 0x3fb8aa3b, v193
  v_mul_f32 v194, 0x3fb8aa3b, v194
  v_mul_f32 v195, 0x3fb8aa3b, v195
  v_mul_f32 v196, 0x3fb8aa3b, v196
  v_mul_f32 v197, 0x3fb8aa3b, v197
  v_mul_f32 v198, 0x3fb8aa3b, v198
  v_mul_f32 v199, 0x3fb8aa3b, v199
  v_exp_f32 v192, v192
  v_exp_f32 v193, v193
  v_exp_f32 v194, v194
  v_exp_f32 v195, v195
  v_exp_f32 v196, v196
  v_exp_f32 v197, v197
  v_exp_f32 v198, v198
  v_exp_f32 v199, v199
  v_cvt_pk_bf16_f32 v176, v192, 0
  v_cvt_pk_bf16_f32 v184, 0, v192
  v_cvt_pk_bf16_f32 v177, v193, 0
  v_cvt_pk_bf16_f32 v185, 0, v193
  v_cvt_pk_bf16_f32 v178, v194, 0
  v_cvt_pk_bf16_f32 v186, 0, v194
  v_cvt_pk_bf16_f32 v179, v195, 0
  v_cvt_pk_bf16_f32 v187, 0, v195
  v_cvt_pk_bf16_f32 v180, v196, 0
  v_cvt_pk_bf16_f32 v188, 0, v196
  v_cvt_pk_bf16_f32 v181, v197, 0
  v_cvt_pk_bf16_f32 v189, 0, v197
  v_cvt_pk_bf16_f32 v182, v198, 0
  v_cvt_pk_bf16_f32 v190, 0, v198
  v_cvt_pk_bf16_f32 v183, v199, 0
  v_cvt_pk_bf16_f32 v191, 0, v199
  v_add_f32 v236, v192, v193
  v_add_f32 v2, v194, v195
  v_add_f32 v3, v196, v197
  v_add_f32 v4, v198, v199
  v_add_f32 v236, v236, v2
  v_add_f32 v3, v3, v4
  v_add_f32 v236, v236, v3
  s_nop 1
  v_add_f32_dpp v236, v236, v236 row_ror:8 row_mask:0xf bank_mask:0xf
  v_mov_b32 v2, v236
  s_nop 1
  v_permlane16_swap_b32 v236, v2
  v_add_f32 v236, v236, v2
  v_mov_b32 v2, v236
  s_nop 1
  v_permlane32_swap_b32 v236, v2
  v_add_f32 v236, v236, v2
  v_mov_b32 v2, v235
  v_mov_b32 v3, s28
  v_mov_b32 v4, v236
  v_mov_b32 v5, s28
  s_mov_b64 exec, 1
  buffer_store_dwordx4 v[2:5], v227, s[60:63], 0 offen sc1
  s_mov_b64 exec, -1
  v_mov_b32 v200, 0
  v_mov_b32 v201, 0
  v_mov_b32 v202, 0
  v_mov_b32 v203, 0
  v_mov_b32 v204, 0
  v_mov_b32 v205, 0
  v_mov_b32 v206, 0
  v_mov_b32 v207, 0
  v_mov_b32 v208, 0
  v_mov_b32 v209, 0
  v_mov_b32 v210, 0
  v_mov_b32 v211, 0
  v_mov_b32 v212, 0
  v_mov_b32 v213, 0
  v_mov_b32 v214, 0
  v_mov_b32 v215, 0
  v_mov_b32 v216, 0
  v_mov_b32 v217, 0
  v_mov_b32 v218, 0
  v_mov_b32 v219, 0
  v_mov_b32 v220, 0
  v_mov_b32 v221, 0
  v_mov_b32 v222, 0
  v_mov_b32 v223, 0
  s_setprio 0
  s_waitcnt vmcnt(4)
  buffer_load_dwordx4 v[148:151], v224, s[36:39], s65 offen offset:256 nt
  s_waitcnt vmcnt(4)
  buffer_load_dwordx4 v[152:155], v224, s[36:39], s66 offen offset:0 nt
  v_dot2c_f32_bf16 v200, v128, v176
  v_dot2c_f32_bf16 v201, v128, v184
  v_dot2c_f32_bf16 v202, v129, v176
  v_dot2c_f32_bf16 v203, v129, v184
  v_dot2c_f32_bf16 v204, v130, v176
  v_dot2c_f32_bf16 v205, v130, v184
  v_dot2c_f32_bf16 v206, v131, v176
  v_dot2c_f32_bf16 v207, v131, v184
  v_dot2c_f32_bf16 v208, v132, v176
  v_dot2c_f32_bf16 v209, v132, v184
  v_dot2c_f32_bf16 v210, v133, v176
  v_dot2c_f32_bf16 v211, v133, v184
  v_dot2c_f32_bf16 v212, v134, v176
  v_dot2c_f32_bf16 v213, v134, v184
  v_dot2c_f32_bf16 v214, v135, v176
  v_dot2c_f32_bf16 v215, v135, v184
  v_dot2c_f32_bf16 v216, v136, v176
  v_dot2c_f32_bf16 v217, v136, v184
  v_dot2c_f32_bf16 v218, v137, v176
  v_dot2c_f32_bf16 v219, v137, v184
  v_dot2c_f32_bf16 v220, v138, v176
  v_dot2c_f32_bf16 v221, v138, v184
  v_dot2c_f32_bf16 v222, v139, v176
  v_dot2c_f32_bf16 v223, v139, v184
  s_waitcnt vmcnt(4)
  buffer_load_dwordx4 v[156:159], v224, s[36:39], s66 offen offset:128 nt
  s_waitcnt vmcnt(4)
  buffer_load_dwordx4 v[160:163], v224, s[36:39], s66 offen offset:256 nt
  s_waitcnt vmcnt(4)
  buffer_load_dwordx4 v[32:35], v224, s[36:39], s67 offen offset:0 nt
  s_waitcnt vmcnt(4)
  buffer_load_dwordx4 v[36:39], v224, s[36:39], s67 offen offset:128 nt
  v_dot2c_f32_bf16 v200, v140, v177
  v_dot2c_f32_bf16 v201, v140, v185
  v_dot2c_f32_bf16 v202, v141, v177
  v_dot2c_f32_bf16 v203, v141, v185
  v_dot2c_f32_bf16 v204, v142, v177
  v_dot2c_f32_bf16 v205, v142, v185
  v_dot2c_f32_bf16 v206, v143, v177
  v_dot2c_f32_bf16 v207, v143, v185
  v_dot2c_f32_bf16 v208, v144, v177
  v_dot2c_f32_bf16 v209, v144, v185
  v_dot2c_f32_bf16 v210, v145, v177
  v_dot2c_f32_bf16 v211, v145, v185
  v_dot2c_f32_bf16 v212, v146, v177
  v_dot2c_f32_bf16 v213, v146, v185
  v_dot2c_f32_bf16 v214, v147, v177
  v_dot2c_f32_bf16 v215, v147, v185
  v_dot2c_f32_bf16 v216, v148, v177
  v_dot2c_f32_bf16 v217, v148, v185
  v_dot2c_f32_bf16 v218, v149, v177
  v_dot2c_f32_bf16 v219, v149, v185
  v_dot2c_f32_bf16 v220, v150, v177
  v_dot2c_f32_bf16 v221, v150, v185
  v_dot2c_f32_bf16 v222, v151, v177
  v_dot2c_f32_bf16 v223, v151, v185
  s_waitcnt vmcnt(4)
  buffer_load_dwordx4 v[40:43], v224, s[36:39], s67 offen offset:256 nt
  s_waitcnt vmcnt(4)
  buffer_load_dwordx4 v[44:47], v224, s[36:39], s68 offen offset:0 nt
  s_waitcnt vmcnt(4)
  buffer_load_dwordx4 v[48:51], v224, s[36:39], s68 offen offset:128 nt
  v_dot2c_f32_bf16 v200, v152, v178
  v_dot2c_f32_bf16 v201, v152, v186
  v_dot2c_f32_bf16 v202, v153, v178
  v_dot2c_f32_bf16 v203, v153, v186
  v_dot2c_f32_bf16 v204, v154, v178
  v_dot2c_f32_bf16 v205, v154, v186
  v_dot2c_f32_bf16 v206, v155, v178
  v_dot2c_f32_bf16 v207, v155, v186
  v_dot2c_f32_bf16 v208, v156, v178
  v_dot2c_f32_bf16 v209, v156, v186
  v_dot2c_f32_bf16 v210, v157, v178
  v_dot2c_f32_bf16 v211, v157, v186
  v_dot2c_f32_bf16 v212, v158, v178
  v_dot2c_f32_bf16 v213, v158, v186
  v_dot2c_f32_bf16 v214, v159, v178
  v_dot2c_f32_bf16 v215, v159, v186
  v_dot2c_f32_bf16 v216, v160, v178
  v_dot2c_f32_bf16 v217, v160, v186
  v_dot2c_f32_bf16 v218, v161, v178
  v_dot2c_f32_bf16 v219, v161, v186
  v_dot2c_f32_bf16 v220, v162, v178
  v_dot2c_f32_bf16 v221, v162, v186
  v_dot2c_f32_bf16 v222, v163, v178
  v_dot2c_f32_bf16 v223, v163, v186
  s_waitcnt vmcnt(4)
  buffer_load_dwordx4 v[52:55], v224, s[36:39], s68 offen offset:256 nt
  s_waitcnt vmcnt(4)
  buffer_load_dwordx4 v[8:11], v228, s[60:63], 0 offen sc1
  s_waitcnt vmcnt(4)
  buffer_load_dwordx4 v[12:15], v229, s[60:63], 0 offen sc1
  v_dot2c_f32_bf16 v200, v32, v179
  v_dot2c_f32_bf16 v201, v32, v187
  v_dot2c_f32_bf16 v202, v33, v179
  v_dot2c_f32_bf16 v203, v33, v187
  v_dot2c_f32_bf16 v204, v34, v179
  v_dot2c_f32_bf16 v205, v34, v187
  v_dot2c_f32_bf16 v206, v35, v179
  v_dot2c_f32_bf16 v207, v35, v187
  v_dot2c_f32_bf16 v208, v36, v179
  v_dot2c_f32_bf16 v209, v36, v187
  v_dot2c_f32_bf16 v210, v37, v179
  v_dot2c_f32_bf16 v211, v37, v187
  v_dot2c_f32_bf16 v212, v38, v179
  v_dot2c_f32_bf16 v213, v38, v187
  v_dot2c_f32_bf16 v214, v39, v179
  v_dot2c_f32_bf16 v215, v39, v187
  v_dot2c_f32_bf16 v216, v40, v179
  v_dot2c_f32_bf16 v217, v40, v187
  v_dot2c_f32_bf16 v218, v41, v179
  v_dot2c_f32_bf16 v219, v41, v187
  v_dot2c_f32_bf16 v220, v42, v179
  v_dot2c_f32_bf16 v221, v42, v187
  v_dot2c_f32_bf16 v222, v43, v179
  v_dot2c_f32_bf16 v223, v43, v187
  s_waitcnt vmcnt(4)
  global_load_ushort v234, v234, s[4:5]
  s_waitcnt vmcnt(4)
  buffer_load_dwordx4 v[56:59], v224, s[36:39], s69 offen offset:0 nt
  s_waitcnt vmcnt(4)
  buffer_load_dwordx4 v[60:63], v224, s[36:39], s69 offen offset:128 nt
  v_dot2c_f32_bf16 v200, v44, v180
  v_dot2c_f32_bf16 v201, v44, v188
  v_dot2c_f32_bf16 v202, v45, v180
  v_dot2c_f32_bf16 v203, v45, v188
  v_dot2c_f32_bf16 v204, v46, v180
  v_dot2c_f32_bf16 v205, v46, v188
  v_dot2c_f32_bf16 v206, v47, v180
  v_dot2c_f32_bf16 v207, v47, v188
  v_dot2c_f32_bf16 v208, v48, v180
  v_dot2c_f32_bf16 v209, v48, v188
  v_dot2c_f32_bf16 v210, v49, v180
  v_dot2c_f32_bf16 v211, v49, v188
  v_dot2c_f32_bf16 v212, v50, v180
  v_dot2c_f32_bf16 v213, v50, v188
  v_dot2c_f32_bf16 v214, v51, v180
  v_dot2c_f32_bf16 v215, v51, v188
  v_dot2c_f32_bf16 v216, v52, v180
  v_dot2c_f32_bf16 v217, v52, v188
  v_dot2c_f32_bf16 v218, v53, v180
  v_dot2c_f32_bf16 v219, v53, v188
  v_dot2c_f32_bf16 v220, v54, v180
  v_dot2c_f32_bf16 v221, v54, v188
  v_dot2c_f32_bf16 v222, v55, v180
  v_dot2c_f32_bf16 v223, v55, v188
  s_waitcnt vmcnt(4)
  buffer_load_dwordx4 v[64:67], v224, s[36:39], s69 offen offset:256 nt
  s_waitcnt vmcnt(4)
  buffer_load_dwordx4 v[68:71], v224, s[36:39], s70 offen offset:0 nt
  s_waitcnt vmcnt(4)
  buffer_load_dwordx4 v[72:75], v224, s[36:39], s70 offen offset:128 nt
  s_waitcnt vmcnt(4)
  buffer_load_dwordx4 v[76:79], v224, s[36:39], s70 offen offset:256 nt
  s_waitcnt vmcnt(4)
  buffer_load_dwordx4 v[80:83], v224, s[36:39], s71 offen offset:0 nt
  s_waitcnt vmcnt(4)
  buffer_load_dwordx4 v[84:87], v224, s[36:39], s71 offen offset:128 nt
  v_dot2c_f32_bf16 v200, v56, v181
  v_dot2c_f32_bf16 v201, v56, v189
  v_dot2c_f32_bf16 v202, v57, v181
  v_dot2c_f32_bf16 v203, v57, v189
  v_dot2c_f32_bf16 v204, v58, v181
  v_dot2c_f32_bf16 v205, v58, v189
  v_dot2c_f32_bf16 v206, v59, v181
  v_dot2c_f32_bf16 v207, v59, v189
  v_dot2c_f32_bf16 v208, v60, v181
  v_dot2c_f32_bf16 v209, v60, v189
  v_dot2c_f32_bf16 v210, v61, v181
  v_dot2c_f32_bf16 v211, v61, v189
  v_dot2c_f32_bf16 v212, v62, v181
  v_dot2c_f32_bf16 v213, v62, v189
  v_dot2c_f32_bf16 v214, v63, v181
  v_dot2c_f32_bf16 v215, v63, v189
  v_dot2c_f32_bf16 v216, v64, v181
  v_dot2c_f32_bf16 v217, v64, v189
  v_dot2c_f32_bf16 v218, v65, v181
  v_dot2c_f32_bf16 v219, v65, v189
  v_dot2c_f32_bf16 v220, v66, v181
  v_dot2c_f32_bf16 v221, v66, v189
  v_dot2c_f32_bf16 v222, v67, v181
  v_dot2c_f32_bf16 v223, v67, v189
  s_waitcnt vmcnt(4)
  buffer_load_dwordx4 v[88:91], v224, s[36:39], s71 offen offset:256 nt
  s_waitcnt vmcnt(4)
  buffer_load_dwordx4 v[108:111], v232, s[56:59], 0 offen nt
  s_waitcnt vmcnt(4)
  buffer_load_dwordx4 v[92:95], v231, s[44:47], 0 offen offset:0 nt
  v_dot2c_f32_bf16 v200, v68, v182
  v_dot2c_f32_bf16 v201, v68, v190
  v_dot2c_f32_bf16 v202, v69, v182
  v_dot2c_f32_bf16 v203, v69, v190
  v_dot2c_f32_bf16 v204, v70, v182
  v_dot2c_f32_bf16 v205, v70, v190
  v_dot2c_f32_bf16 v206, v71, v182
  v_dot2c_f32_bf16 v207, v71, v190
  v_dot2c_f32_bf16 v208, v72, v182
  v_dot2c_f32_bf16 v209, v72, v190
  v_dot2c_f32_bf16 v210, v73, v182
  v_dot2c_f32_bf16 v211, v73, v190
  v_dot2c_f32_bf16 v212, v74, v182
  v_dot2c_f32_bf16 v213, v74, v190
  v_dot2c_f32_bf16 v214, v75, v182
  v_dot2c_f32_bf16 v215, v75, v190
  v_dot2c_f32_bf16 v216, v76, v182
  v_dot2c_f32_bf16 v217, v76, v190
  v_dot2c_f32_bf16 v218, v77, v182
  v_dot2c_f32_bf16 v219, v77, v190
  v_dot2c_f32_bf16 v220, v78, v182
  v_dot2c_f32_bf16 v221, v78, v190
  v_dot2c_f32_bf16 v222, v79, v182
  v_dot2c_f32_bf16 v223, v79, v190
  v_cmp_ne_u32 vcc, s28, v9
  v_cmp_ne_u32 s[80:81], s28, v11
  s_or_b64 vcc, vcc, s[80:81]
  s_cmp_eq_u64 vcc, 0
  s_cbranch_scc1 Lp_done_8
  s_mov_b32 s90, 0
  s_mov_b64 s[82:83], exec
Lp_loop_9:
  s_mov_b64 exec, vcc
  s_sleep 2
  buffer_load_dwordx4 v[8:11], v228, s[60:63], 0 offen sc1
  s_waitcnt vmcnt(0)
  v_cmp_ne_u32 vcc, s28, v9
  v_cmp_ne_u32 s[80:81], s28, v11
  s_or_b64 vcc, vcc, s[80:81]
  s_mov_b64 exec, s[82:83]
  s_add_u32 s90, s90, 1
  s_cmp_ge_u32 s90, 200000
  s_cbranch_scc1 Lp_done_8
  s_cmp_eq_u64 vcc, 0
  s_cbranch_scc0 Lp_loop_9
Lp_done_8:
  s_nop 1
  v_mov_b32 v16, v8
  s_nop 1
  v_max_f32_dpp v16, v16, v16 quad_perm:[1,0,3,2] row_mask:0xf bank_mask:0xf
  s_nop 1
  v_max_f32_dpp v16, v16, v16 quad_perm:[2,3,0,1] row_mask:0xf bank_mask:0xf
  s_nop 1
  v_max_f32_dpp v16, v16, v16 row_half_mirror row_mask:0xf bank_mask:0xf
  s_nop 1
  v_max_f32_dpp v16, v16, v16 row_mirror row_mask:0xf bank_mask:0xf
  v_mov_b32 v17, v16
  s_nop 1
  v_permlane16_swap_b32 v16, v17
  v_max_f32 v16, v16, v17
  v_mov_b32 v17, v16
  s_nop 1
  v_permlane32_swap_b32 v16, v17
  v_max_f32 v16, v16, v17
  v_sub_f32 v17, v8, v16
  v_mul_f32 v17, 0x3fb8aa3b, v17
  v_exp_f32 v17, v17
  s_nop 0
  v_mul_f32 v17, v17, v10
  s_nop 1
  v_add_f32_dpp v17, v17, v17 quad_perm:[1,0,3,2] row_mask:0xf bank_mask:0xf
  s_nop 1
  v_add_f32_dpp v17, v17, v17 quad_perm:[2,3,0,1] row_mask:0xf bank_mask:0xf
  s_nop 1
  v_add_f32_dpp v17, v17, v17 row_half_mirror row_mask:0xf bank_mask:0xf
  s_nop 1
  v_add_f32_dpp v17, v17, v17 row_mirror row_mask:0xf bank_mask:0xf
  v_mov_b32 v18, v17
  s_nop 1
  v_permlane16_swap_b32 v17, v18
  v_add_f32 v17, v17, v18
  v_mov_b32 v18, v17
  s_nop 1
  v_permlane32_swap_b32 v17, v18
  v_add_f32 v17, v17, v18
  v_sub_f32 v18, v235, v16
  v_mul_f32 v18, 0x3fb8aa3b, v18
  v_exp_f32 v18, v18
  v_rcp_f32 v17, v17
  s_nop 0
  v_mul_f32 v235, v18, v17
  s_cmp_eq_u32 s91, 0
  s_cbranch_scc1 L_noh_10
  v_cmp_ne_u32 vcc, s28, v13
  v_cmp_ne_u32 s[80:81], s28, v15
  s_or_b64 vcc, vcc, s[80:81]
  s_cmp_eq_u64 vcc, 0
  s_cbranch_scc1 Lp_done_11
  s_mov_b32 s90, 0
  s_mov_b64 s[82:83], exec
Lp_loop_12:
  s_mov_b64 exec, vcc
  s_sleep 2
  buffer_load_dwordx4 v[12:15], v229, s[60:63], 0 offen sc1
  s_waitcnt vmcnt(0)
  v_cmp_ne_u32 vcc, s28, v13
  v_cmp_ne_u32 s[80:81], s28, v15
  s_or_b64 vcc, vcc, s[80:81]
  s_mov_b64 exec, s[82:83]
  s_add_u32 s90, s90, 1
  s_cmp_ge_u32 s90, 200000
  s_cbranch_scc1 Lp_done_11
  s_cmp_eq_u64 vcc, 0
  s_cbranch_scc0 Lp_loop_12
Lp_done_11:
  s_nop 1
  v_and_b32 v16, 15, v1
  v_cmp_gt_u32 vcc, 10, v16
  s_nop 1
  v_cndmask_b32 v12, 0, v12, vcc
  v_cndmask_b32 v14, 0, v14, vcc
  s_nop 0
  v_add_f32_dpp v12, v12, v12 quad_perm:[1,0,3,2] row_mask:0xf bank_mask:0xf
  v_add_f32_dpp v14, v14, v14 quad_perm:[1,0,3,2] row_mask:0xf bank_mask:0xf
  s_nop 0
  v_add_f32_dpp v12, v12, v12 quad_perm:[2,3,0,1] row_mask:0xf bank_mask:0xf
  v_add_f32_dpp v14, v14, v14 quad_perm:[2,3,0,1] row_mask:0xf bank_mask:0xf
  s_nop 0
  v_add_f32_dpp v12, v12, v12 row_half_mirror row_mask:0xf bank_mask:0xf
  v_add_f32_dpp v14, v14, v14 row_half_mirror row_mask:0xf bank_mask:0xf
  s_nop 0
  v_add_f32_dpp v12, v12, v12 row_mirror row_mask:0xf bank_mask:0xf
  v_add_f32_dpp v14, v14, v14 row_mirror row_mask:0xf bank_mask:0xf
  v_mov_b32 v16, v12
  v_mov_b32 v17, v14
  s_nop 0
  v_permlane32_swap_b32 v12, v16
  v_permlane32_swap_b32 v14, v17
  v_cmp_gt_u32 vcc, 32, v1
  s_nop 1
  v_cndmask_b32 v18, v14, v12, vcc
  v_cndmask_b32 v19, v17, v16, vcc
  v_cvt_pk_bf16_f32 v18, v18, v18
  v_and_b32 v18, 0xffff0000, v18
  v_cvt_pk_bf16_f32 v19, v19, v19
  v_and_b32 v19, 0xffff0000, v19
  v_mul_f32 v20, 0xbfb8aa3b, v18
  v_exp_f32 v20, v20
  s_nop 0
  v_add_f32 v20, 1.0, v20
  v_rcp_f32 v20, v20
  s_nop 0
  v_mul_f32 v18, v18, v20
  v_cvt_pk_bf16_f32 v18, v18, v18
  v_and_b32 v18, 0xffff0000, v18
  v_mul_f32 v18, v18, v19
  v_cvt_pk_bf16_f32 v237, v18, 0
  v_cvt_pk_bf16_f32 v238, 0, v18
L_noh_10:
  s_nop 1
  v_mov_b32 v21, s28
  v_mov_b32 v23, s28
  v_lshlrev_b32 v28, 3, v0
  v_lshlrev_b32 v29, 2, v0
  v_and_b32 v8, 8, v1
  v_cmp_eq_u32 s[86:87], 0, v8
  s_waitcnt vmcnt(4)
  buffer_load_dwordx4 v[96:99], v231, s[44:47], 0 offen offset:1280 nt
  s_waitcnt vmcnt(4)
  buffer_load_dwordx4 v[100:103], v231, s[44:47], 0 offen offset:2560 nt
  s_waitcnt vmcnt(4)
  buffer_load_dwordx4 v[104:107], v231, s[44:47], 0 offen offset:3840 nt
  v_dot2c_f32_bf16 v200, v80, v183
  v_dot2c_f32_bf16 v201, v80, v191
  v_dot2c_f32_bf16 v202, v81, v183
  v_dot2c_f32_bf16 v203, v81, v191
  v_dot2c_f32_bf16 v204, v82, v183
  v_dot2c_f32_bf16 v205, v82, v191
  v_dot2c_f32_bf16 v206, v83, v183
  v_dot2c_f32_bf16 v207, v83, v191
  v_dot2c_f32_bf16 v208, v84, v183
  v_dot2c_f32_bf16 v209, v84, v191
  v_dot2c_f32_bf16 v210, v85, v183
  v_dot2c_f32_bf16 v211, v85, v191
  v_dot2c_f32_bf16 v212, v86, v183
  v_dot2c_f32_bf16 v213, v86, v191
  v_dot2c_f32_bf16 v214, v87, v183
  v_dot2c_f32_bf16 v215, v87, v191
  v_dot2c_f32_bf16 v216, v88, v183
  v_dot2c_f32_bf16 v217, v88, v191
  v_dot2c_f32_bf16 v218, v89, v183
  v_dot2c_f32_bf16 v219, v89, v191
  v_dot2c_f32_bf16 v220, v90, v183
  v_dot2c_f32_bf16 v221, v90, v191
  v_dot2c_f32_bf16 v222, v91, v183
  v_dot2c_f32_bf16 v223, v91, v191
  v_permlane32_swap_b32 v200, v204
  v_permlane32_swap_b32 v201, v205
  v_permlane32_swap_b32 v202, v206
  v_permlane32_swap_b32 v203, v207
  v_permlane32_swap_b32 v208, v212
  v_permlane32_swap_b32 v209, v213
  v_permlane32_swap_b32 v210, v214
  v_permlane32_swap_b32 v211, v215
  v_permlane32_swap_b32 v216, v220
  v_permlane32_swap_b32 v217, v221
  v_permlane32_swap_b32 v218, v222
  v_permlane32_swap_b32 v219, v223
  v_add_f32 v200, v200, v204
  v_add_f32 v201, v201, v205
  v_add_f32 v202, v202, v206
  v_add_f32 v203, v203, v207
  v_add_f32 v208, v208, v212
  v_add_f32 v209, v209, v213
  v_add_f32 v210, v210, v214
  v_add_f32 v211, v211, v215
  v_add_f32 v216, v216, v220
  v_add_f32 v217, v217, v221
  v_add_f32 v218, v218, v222
  v_add_f32 v219, v219, v223
  v_permlane16_swap_b32 v200, v202
  v_permlane16_swap_b32 v201, v203
  v_permlane16_swap_b32 v208, v210
  v_permlane16_swap_b32 v209, v211
  v_permlane16_swap_b32 v216, v218
  v_permlane16_swap_b32 v217, v219
  v_add_f32 v200, v200, v202
  v_add_f32 v201, v201, v203
  v_add_f32 v208, v208, v210
  v_add_f32 v209, v209, v211
  v_add_f32 v216, v216, v218
  v_add_f32 v217, v217, v219
  v_add_f32_dpp v200, v200, v200 row_ror:8 row_mask:0xf bank_mask:0xf
  v_add_f32_dpp v201, v201, v201 row_ror:8 row_mask:0xf bank_mask:0xf
  v_add_f32_dpp v208, v208, v208 row_ror:8 row_mask:0xf bank_mask:0xf
  v_add_f32_dpp v209, v209, v209 row_ror:8 row_mask:0xf bank_mask:0xf
  v_add_f32_dpp v216, v216, v216 row_ror:8 row_mask:0xf bank_mask:0xf
  v_add_f32_dpp v217, v217, v217 row_ror:8 row_mask:0xf bank_mask:0xf
  v_mul_f32 v200, v235, v200
  v_mul_f32 v201, v235, v201
  v_mul_f32 v208, v235, v208
  v_mul_f32 v209, v235, v209
  v_mul_f32 v216, v235, v216
  v_mul_f32 v217, v235, v217
  ds_write_b64 v241, v[200:201] offset:11904
  ds_write_b64 v241, v[208:209] offset:12160
  ds_write_b64 v241, v[216:217] offset:12416
  s_waitcnt lgkmcnt(0)
  s_barrier
  s_cmp_ge_u32 s29, 2
  s_cbranch_scc1 L_pub3_13
  ds_read_b64 v[2:3], v28 offset:11904
  ds_read_b64 v[4:5], v28 offset:12672
  ds_read_b64 v[6:7], v28 offset:13440
  ds_read_b64 v[8:9], v28 offset:14208
  ds_read_b64 v[10:11], v28 offset:14976
  ds_read_b64 v[12:13], v28 offset:15744
  ds_read_b64 v[14:15], v28 offset:16512
  ds_read_b64 v[16:17], v28 offset:17280
  v_cmp_gt_u32 vcc, 96, v0
  s_waitcnt lgkmcnt(0)
  v_add_f32 v2, v2, v4
  v_add_f32 v6, v6, v8
  v_add_f32 v10, v10, v12
  v_add_f32 v14, v14, v16
  v_add_f32 v2, v2, v6
  v_add_f32 v10, v10, v14
  v_add_f32 v20, v2, v10
  v_add_f32 v3, v3, v5
  v_add_f32 v7, v7, v9
  v_add_f32 v11, v11, v13
  v_add_f32 v15, v15, v17
  v_add_f32 v3, v3, v7
  v_add_f32 v11, v11, v15
  v_add_f32 v22, v3, v11
  s_and_saveexec_b64 s[82:83], vcc
  s_cbranch_execz L_pub3_13_r
  buffer_store_dwordx4 v[20:23], v243, s[60:63], s79 offen
  buffer_store_dwordx4 v[20:23], v243, s[60:63], 0 offen sc1
L_pub3_13_r:
  s_mov_b64 exec, s[82:83]
L_pub3_13:
  s_cmp_eq_u32 s91, 0
  s_cbranch_scc1 L_fin
  buffer_load_dwordx4 v[2:5], v230, s[60:63], s79 offen sc1
  v_mov_b32 v200, 0
  v_mov_b32 v201, 0
  v_mov_b32 v202, 0
  v_mov_b32 v203, 0
  v_mov_b32 v204, 0
  v_mov_b32 v205, 0
  v_mov_b32 v206, 0
  v_mov_b32 v207, 0
  v_mov_b32 v208, 0
  v_mov_b32 v209, 0
  v_mov_b32 v210, 0
  v_mov_b32 v211, 0
  v_mov_b32 v212, 0
  v_mov_b32 v213, 0
  v_mov_b32 v214, 0
  v_mov_b32 v215, 0
  s_waitcnt vmcnt(5)
  v_dot2c_f32_bf16 v208, v108, v237
  v_dot2c_f32_bf16 v209, v108, v238
  v_dot2c_f32_bf16 v210, v109, v237
  v_dot2c_f32_bf16 v211, v109, v238
  v_dot2c_f32_bf16 v212, v110, v237
  v_dot2c_f32_bf16 v213, v110, v238
  v_dot2c_f32_bf16 v214, v111, v237
  v_dot2c_f32_bf16 v215, v111, v238
  s_waitcnt vmcnt(0)
  v_cmp_ne_u32 vcc, s28, v3
  v_cmp_ne_u32 s[80:81], s28, v5
  s_or_b64 vcc, vcc, s[80:81]
  s_cmp_eq_u64 vcc, 0
  s_cbranch_scc1 Ld_done_14
  s_mov_b32 s90, 0
Ld_loop_15:
  s_mov_b64 exec, vcc
  buffer_load_dwordx4 v[2:5], v230, s[60:63], s79 offen sc1
  s_waitcnt vmcnt(0)
  v_cmp_ne_u32 vcc, s28, v3
  v_cmp_ne_u32 s[80:81], s28, v5
  s_or_b64 vcc, vcc, s[80:81]
  s_cmp_eq_u64 vcc, 0
  s_cbranch_scc1 Ld_done_14_x
  s_add_u32 s90, s90, 1
  s_cmp_lt_u32 s90, 64
  s_cbranch_scc1 Ld_loop_15
  s_mov_b64 exec, vcc
  buffer_load_dwordx4 v[2:5], v230, s[60:63], 0 offen sc1
  s_waitcnt vmcnt(0)
  v_cmp_ne_u32 vcc, s28, v3
  v_cmp_ne_u32 s[80:81], s28, v5
  s_or_b64 vcc, vcc, s[80:81]
  s_cmp_eq_u64 vcc, 0
  s_cbranch_scc1 Ld_done_14_x
  s_cmp_lt_u32 s90, 200000
  s_cbranch_scc1 Ld_loop_15
Ld_done_14_x:
  s_mov_b64 exec, -1
Ld_done_14:
  s_nop 1
  v_add_f32_dpp v2, v2, v2 quad_perm:[1,0,3,2] row_mask:0xf bank_mask:0xf
  v_add_f32_dpp v4, v4, v4 quad_perm:[1,0,3,2] row_mask:0xf bank_mask:0xf
  s_nop 0
  v_add_f32_dpp v2, v2, v2 quad_perm:[2,3,0,1] row_mask:0xf bank_mask:0xf
  v_add_f32_dpp v4, v4, v4 quad_perm:[2,3,0,1] row_mask:0xf bank_mask:0xf
  s_nop 0
  v_add_f32_dpp v2, v2, v2 row_half_mirror row_mask:0xf bank_mask:0xf
  v_add_f32_dpp v4, v4, v4 row_half_mirror row_mask:0xf bank_mask:0xf
  s_nop 0
  v_mov_b32_dpp v6, v2 row_ror:8 row_mask:0xf bank_mask:0xf
  v_mov_b32_dpp v7, v4 row_ror:8 row_mask:0xf bank_mask:0xf
  v_cndmask_b32 v10, v6, v2, s[86:87]
  v_cndmask_b32 v11, v7, v4, s[86:87]
  v_cndmask_b32 v12, v2, v6, s[86:87]
  v_cndmask_b32 v13, v4, v7, s[86:87]
  v_cvt_pk_bf16_f32 v14, v10, 0
  v_cvt_pk_bf16_f32 v24, 0, v10
  v_cvt_pk_bf16_f32 v15, v11, 0
  v_cvt_pk_bf16_f32 v25, 0, v11
  v_cvt_pk_bf16_f32 v16, v12, 0
  v_cvt_pk_bf16_f32 v26, 0, v12
  v_cvt_pk_bf16_f32 v17, v13, 0
  v_cvt_pk_bf16_f32 v27, 0, v13
  v_dot2c_f32_bf16 v200, v92, v14
  v_dot2c_f32_bf16 v201, v92, v24
  v_dot2c_f32_bf16 v202, v93, v14
  v_dot2c_f32_bf16 v203, v93, v24
  v_dot2c_f32_bf16 v204, v94, v14
  v_dot2c_f32_bf16 v205, v94, v24
  v_dot2c_f32_bf16 v206, v95, v14
  v_dot2c_f32_bf16 v207, v95, v24
  v_dot2c_f32_bf16 v200, v96, v15
  v_dot2c_f32_bf16 v201, v96, v25
  v_dot2c_f32_bf16 v202, v97, v15
  v_dot2c_f32_bf16 v203, v97, v25
  v_dot2c_f32_bf16 v204, v98, v15
  v_dot2c_f32_bf16 v205, v98, v25
  v_dot2c_f32_bf16 v206, v99, v15
  v_dot2c_f32_bf16 v207, v99, v25
  v_dot2c_f32_bf16 v200, v100, v16
  v_dot2c_f32_bf16 v201, v100, v26
  v_dot2c_f32_bf16 v202, v101, v16
  v_dot2c_f32_bf16 v203, v101, v26
  v_dot2c_f32_bf16 v204, v102, v16
  v_dot2c_f32_bf16 v205, v102, v26
  v_dot2c_f32_bf16 v206, v103, v16
  v_dot2c_f32_bf16 v207, v103, v26
  v_dot2c_f32_bf16 v200, v104, v17
  v_dot2c_f32_bf16 v201, v104, v27
  v_dot2c_f32_bf16 v202, v105, v17
  v_dot2c_f32_bf16 v203, v105, v27
  v_dot2c_f32_bf16 v204, v106, v17
  v_dot2c_f32_bf16 v205, v106, v27
  v_dot2c_f32_bf16 v206, v107, v17
  v_dot2c_f32_bf16 v207, v107, v27
  v_permlane32_swap_b32 v200, v208
  v_permlane32_swap_b32 v201, v209
  v_permlane32_swap_b32 v202, v210
  v_permlane32_swap_b32 v203, v211
  v_permlane32_swap_b32 v204, v212
  v_permlane32_swap_b32 v205, v213
  v_permlane32_swap_b32 v206, v214
  v_permlane32_swap_b32 v207, v215
  v_add_f32 v200, v200, v208
  v_add_f32 v201, v201, v209
  v_add_f32 v202, v202, v210
  v_add_f32 v203, v203, v211
  v_add_f32 v204, v204, v212
  v_add_f32 v205, v205, v213
  v_add_f32 v206, v206, v214
  v_add_f32 v207, v207, v215
  v_permlane16_swap_b32 v200, v204
  v_permlane16_swap_b32 v201, v205
  v_permlane16_swap_b32 v202, v206
  v_permlane16_swap_b32 v203, v207
  v_add_f32 v200, v200, v204
  v_add_f32 v201, v201, v205
  v_add_f32 v202, v202, v206
  v_add_f32 v203, v203, v207
  ds_write_b128 v242, v[200:203] offset:18048
  s_waitcnt lgkmcnt(0)
  s_barrier
  s_cmp_ge_u32 s29, 2
  s_cbranch_scc1 L_pub4_16
  ds_read_b32 v2, v29 offset:18048
  ds_read_b32 v10, v29 offset:18560
  ds_read_b32 v3, v29 offset:19072
  ds_read_b32 v11, v29 offset:19584
  ds_read_b32 v4, v29 offset:20096
  ds_read_b32 v12, v29 offset:20608
  ds_read_b32 v5, v29 offset:21120
  ds_read_b32 v13, v29 offset:21632
  ds_read_b32 v6, v29 offset:22144
  ds_read_b32 v14, v29 offset:22656
  ds_read_b32 v7, v29 offset:23168
  ds_read_b32 v15, v29 offset:23680
  ds_read_b32 v8, v29 offset:24192
  ds_read_b32 v16, v29 offset:24704
  ds_read_b32 v9, v29 offset:25216
  ds_read_b32 v17, v29 offset:25728
  s_waitcnt lgkmcnt(0)
  v_add_f32 v2, v2, v3
  v_add_f32 v4, v4, v5
  v_add_f32 v6, v6, v7
  v_add_f32 v8, v8, v9
  v_add_f32 v2, v2, v4
  v_add_f32 v6, v6, v8
  v_add_f32 v20, v2, v6
  v_add_f32 v10, v10, v11
  v_add_f32 v12, v12, v13
  v_add_f32 v14, v14, v15
  v_add_f32 v16, v16, v17
  v_add_f32 v10, v10, v12
  v_add_f32 v14, v14, v16
  v_add_f32 v22, v10, v14
  buffer_store_dwordx4 v[20:23], v244, s[60:63], 0 offen sc1
L_pub4_16:
L_fin:
  s_cmp_lg_u32 s29, 2
  s_cbranch_scc1 L_done
  s_cmp_ge_u32 s2, 160
  s_cbranch_scc1 L_done
  buffer_load_dwordx4 v[2:5], v233, s[60:63], 0 offen sc1
  buffer_load_dwordx4 v[6:9], v233, s[60:63], s88 offen sc1
  buffer_load_dwordx4 v[10:13], v233, s[60:63], s89 offen sc1
  s_waitcnt vmcnt(0)
  v_cmp_ne_u32 vcc, s28, v3
  v_cmp_ne_u32 s[80:81], s28, v5
  s_or_b64 vcc, vcc, s[80:81]
  v_cmp_ne_u32 s[80:81], s28, v7
  s_or_b64 vcc, vcc, s[80:81]
  v_cmp_ne_u32 s[80:81], s28, v9
  s_or_b64 vcc, vcc, s[80:81]
  v_cmp_ne_u32 s[80:81], s28, v11
  s_or_b64 vcc, vcc, s[80:81]
  v_cmp_ne_u32 s[80:81], s28, v13
  s_or_b64 vcc, vcc, s[80:81]
  s_cmp_eq_u64 vcc, 0
  s_cbranch_scc1 Lf_done_17
  s_mov_b64 s[82:83], vcc
  s_mov_b64 exec, vcc
  s_mov_b32 s90, 0
  buffer_load_dwordx4 v[128:131], v233, s[60:63], 0 offen sc1
  buffer_load_dwordx4 v[132:135], v233, s[60:63], s88 offen sc1
  buffer_load_dwordx4 v[136:139], v233, s[60:63], s89 offen sc1
  s_sleep 8
  buffer_load_dwordx4 v[140:143], v233, s[60:63], 0 offen sc1
  buffer_load_dwordx4 v[144:147], v233, s[60:63], s88 offen sc1
  buffer_load_dwordx4 v[148:151], v233, s[60:63], s89 offen sc1
Lf_loop_18:
  s_waitcnt vmcnt(3)
  v_cmp_ne_u32 vcc, s28, v129
  v_cmp_ne_u32 s[80:81], s28, v131
  s_or_b64 vcc, vcc, s[80:81]
  v_cmp_ne_u32 s[80:81], s28, v133
  s_or_b64 vcc, vcc, s[80:81]
  v_cmp_ne_u32 s[80:81], s28, v135
  s_or_b64 vcc, vcc, s[80:81]
  v_cmp_ne_u32 s[80:81], s28, v137
  s_or_b64 vcc, vcc, s[80:81]
  v_cmp_ne_u32 s[80:81], s28, v139
  s_or_b64 vcc, vcc, s[80:81]
  s_andn2_b64 exec, s[82:83], vcc
  v_mov_b32 v2, v128
  v_mov_b32 v4, v130
  v_mov_b32 v6, v132
  v_mov_b32 v8, v134
  v_mov_b32 v10, v136
  v_mov_b32 v12, v138
  s_and_b64 s[82:83], s[82:83], vcc
  s_cbranch_scc0 Lf_done_17_x
  s_mov_b64 exec, s[82:83]
  buffer_load_dwordx4 v[128:131], v233, s[60:63], 0 offen sc1
  buffer_load_dwordx4 v[132:135], v233, s[60:63], s88 offen sc1
  buffer_load_dwordx4 v[136:139], v233, s[60:63], s89 offen sc1
  s_waitcnt vmcnt(3)
  v_cmp_ne_u32 vcc, s28, v141
  v_cmp_ne_u32 s[80:81], s28, v143
  s_or_b64 vcc, vcc, s[80:81]
  v_cmp_ne_u32 s[80:81], s28, v145
  s_or_b64 vcc, vcc, s[80:81]
  v_cmp_ne_u32 s[80:81], s28, v147
  s_or_b64 vcc, vcc, s[80:81]
  v_cmp_ne_u32 s[80:81], s28, v149
  s_or_b64 vcc, vcc, s[80:81]
  v_cmp_ne_u32 s[80:81], s28, v151
  s_or_b64 vcc, vcc, s[80:81]
  s_andn2_b64 exec, s[82:83], vcc
  v_mov_b32 v2, v140
  v_mov_b32 v4, v142
  v_mov_b32 v6, v144
  v_mov_b32 v8, v146
  v_mov_b32 v10, v148
  v_mov_b32 v12, v150
  s_and_b64 s[82:83], s[82:83], vcc
  s_cbranch_scc0 Lf_done_17_x
  s_mov_b64 exec, s[82:83]
  buffer_load_dwordx4 v[140:143], v233, s[60:63], 0 offen sc1
  buffer_load_dwordx4 v[144:147], v233, s[60:63], s88 offen sc1
  buffer_load_dwordx4 v[148:151], v233, s[60:63], s89 offen sc1
  s_add_u32 s90, s90, 1
  s_cmp_lt_u32 s90, 200000
  s_cbranch_scc1 Lf_loop_18
Lf_done_17_x:
  s_mov_b64 exec, -1
Lf_done_17:
  s_nop 1
  v_add_f32 v2, v2, v6
  v_add_f32 v4, v4, v8
  v_add_f32 v2, v2, v10
  v_add_f32 v4, v4, v12
  s_nop 0
  v_add_f32_dpp v2, v2, v2 row_ror:8 row_mask:0xf bank_mask:0xf
  v_add_f32_dpp v4, v4, v4 row_ror:8 row_mask:0xf bank_mask:0xf
  s_nop 0
  v_add_f32_dpp v2, v2, v2 row_ror:4 row_mask:0xf bank_mask:0xf
  v_add_f32_dpp v4, v4, v4 row_ror:4 row_mask:0xf bank_mask:0xf
  v_mov_b32 v6, v2
  v_mov_b32 v7, v4
  s_nop 0
  v_permlane16_swap_b32 v2, v6
  v_permlane16_swap_b32 v4, v7
  v_add_f32 v2, v2, v6
  v_add_f32 v4, v4, v7
  v_mov_b32 v6, v2
  v_mov_b32 v7, v4
  s_nop 0
  v_permlane32_swap_b32 v2, v6
  v_permlane32_swap_b32 v4, v7
  v_add_f32 v2, v2, v6
  v_add_f32 v4, v4, v7
  v_cvt_pk_bf16_f32 v2, v2, v4
  v_and_b32 v4, 0xffff0000, v2
  v_lshlrev_b32 v2, 16, v2
  v_mul_f32 v6, 0xbfb8aa3b, v4
  v_exp_f32 v6, v6
  s_nop 0
  v_add_f32 v6, 1.0, v6
  v_rcp_f32 v6, v6
  s_nop 0
  v_mul_f32 v4, v4, v6
  v_cvt_pk_bf16_f32 v4, v4, v4
  v_and_b32 v4, 0xffff0000, v4
  v_mul_f32 v2, v2, v4
  v_cvt_pk_bf16_f32 v2, v2, v2
  v_and_b32 v2, 0xffff0000, v2
  v_lshlrev_b32 v6, 16, v234
  v_add_f32 v2, v6, v2
  v_cvt_pk_bf16_f32 v2, v2, v2
  s_lshl_b32 s80, s2, 3
  v_lshl_add_u32 v6, v1, 1, s80
  s_mov_b64 exec, 15
  global_store_short v6, v2, s[22:23]
  s_cmp_lg_u32 s2, 0
  s_cbranch_scc1 L_done
  s_mov_b64 exec, 1
  v_mov_b32 v6, 0
  v_mov_b32 v7, s28
  global_store_dword v6, v7, s[26:27]
L_done:
L_end:
  s_endpgm
.section .rodata,"a"
.p2align 6
.amdhsa_kernel recurrent_scan__mha_block_cached__swiglu_ffn__decode_kernel
  .amdhsa_next_free_vgpr 256
  .amdhsa_next_free_sgpr 102
  .amdhsa_accum_offset 256
  .amdhsa_group_segment_fixed_size 0
  .amdhsa_kernarg_size 96
  .amdhsa_user_sgpr_count 2
  .amdhsa_user_sgpr_kernarg_segment_ptr 1
  .amdhsa_system_sgpr_workgroup_id_x 1
.end_amdhsa_kernel
```
